```python
import torch

def _softmax(x, axis=-1):
    return torch.softmax(x, dim=axis)
def _gelu(x):
    return torch.nn.functional.gelu(x, approximate="tanh")
def _silu(x):
    return torch.nn.functional.silu(x)
def _sigmoid(x):
    return torch.sigmoid(x)
def _layernorm(x, axis=-1, eps=1e-5):
    m = x.mean(dim=axis, keepdim=True)
    v = x.var(dim=axis, keepdim=True, unbiased=False)
    return (x - m) / torch.sqrt(v + eps)
def _scatter_add(tgt, idx, src, axis=0):
    return tgt.clone().index_add_(axis, idx, src)
def _segment_sum(src, seg, n):
    out = torch.zeros((n,) + src.shape[1:], dtype=src.dtype)
    return out.index_add_(0, seg, src)
def _pad(x, pw):
    flat = tuple(v for pair in reversed(pw) for v in pair)
    return torch.nn.functional.pad(x, flat)

kernel_name = 'sequential_preLN__spectral_fnet__dense_activation_relu__prompt'

def setup_inputs():

    _w = (lambda a: (lambda t: t.to(torch.bfloat16) if t.is_floating_point() else t)(torch.as_tensor(a)))
    def _A_setup():
        B, S, D = 1, 2048, 1024
        ns = torch.arange(S)[:, None] * torch.arange(S)[None, :]
        nd = torch.arange(D)[:, None] * torch.arange(D)[None, :]
        Ws_re = torch.cos(-2.0 * torch.pi * ns / S).to(float)
        Ws_im = torch.sin(-2.0 * torch.pi * ns / S).to(float)
        Wd_re = torch.cos(-2.0 * torch.pi * nd / D).to(float)
        Wd_im = torch.sin(-2.0 * torch.pi * nd / D).to(float)
        return {
            "x": _w((lambda *s: torch.randn(*s, dtype=torch.bfloat16) * 0.05)(B, S, D)),
            "dft_seq_re": _w(Ws_re),
            "dft_seq_im": _w(Ws_im),
            "dft_hid_re": _w(Wd_re),
            "dft_hid_im": _w(Wd_im),
        }
    _A_in = _A_setup()

    def _B_setup():
        B, S, D, Dff = 1, 2048, 1024, 3584
        return {
            "x": _w((lambda *s: torch.randn(*s, dtype=torch.bfloat16) * 0.05)(B, S, D)),
            "w1": _w((lambda *s: torch.randn(*s, dtype=torch.bfloat16) * 0.4)(D, Dff)),
            "w2": _w((lambda *s: torch.randn(*s, dtype=torch.bfloat16) * 0.4)(Dff, D)),
        }
    _B_in = _B_setup()

    return {
        "A_x": _A_in["x"],
        "A_dft_seq_re": _A_in["dft_seq_re"],
        "A_dft_seq_im": _A_in["dft_seq_im"],
        "A_dft_hid_re": _A_in["dft_hid_re"],
        "A_dft_hid_im": _A_in["dft_hid_im"],
        "B_x": _B_in["x"],
        "B_w1": _B_in["w1"],
        "B_w2": _B_in["w2"],
    }

def reference(A_x, A_dft_seq_re, A_dft_seq_im, A_dft_hid_re, A_dft_hid_im, B_x, B_w1, B_w2):
    def _A_ref(x, dft_seq_re, dft_seq_im, dft_hid_re, dft_hid_im):
        a = torch.einsum("bsd,ed->bse", x, dft_hid_re)
        b = torch.einsum("bsd,ed->bse", x, dft_hid_im)
        y = torch.einsum("ts,bse->bte", dft_seq_re, a) - torch.einsum("ts,bse->bte", dft_seq_im, b)
        return y

    def _B_ref(x, w1, w2):
        h = torch.einsum("bsd,df->bsf", x, w1)
        zero = torch.zeros_like(h)
        h = torch.maximum(h, zero)
        return torch.einsum("bsf,fd->bsd", h, w2)

    x = A_x
    h = x + _A_ref(_layernorm(x, axis=-1), A_dft_seq_re, A_dft_seq_im, A_dft_hid_re, A_dft_hid_im)
    h2 = h + _B_ref(_layernorm(h, axis=-1), B_w1, B_w2)
    return h2
```

```asm
; @launch kernel=ln_fold_kernel grid=(952,1,1) block=(256,1,1) lds=16448
; @launch kernel=dft_hid_kernel grid=(242,1,1) block=(256,1,1) lds=18432
; @launch kernel=dft_seq_kernel grid=(242,1,1) block=(256,1,1) lds=86016
; @launch kernel=ffn1_kernel grid=(256,1,1) block=(512,1,1) lds=137216
; @launch kernel=ffn2_kernel grid=(256,1,1) block=(512,1,1) lds=147456
.amdgcn_target "amdgcn-amd-amdhsa--gfx950"
.text
.globl ln_fold_kernel
.p2align 8
.type ln_fold_kernel,@function
ln_fold_kernel:
  s_cmp_ge_u32 s2, 952
  s_cbranch_scc1 K1_END
  s_load_dwordx2 s[4:5], s[0:1], 0
  s_load_dwordx2 s[6:7], s[0:1], 48
  s_load_dwordx2 s[8:9], s[0:1], 80
  v_and_b32 v1, 63, v0
  v_lshrrev_b32 v2, 6, v0
  s_nop 0
  v_readfirstlane_b32 s3, v2
  s_waitcnt lgkmcnt(0)
  s_cmp_lt_u32 s2, 112
  s_cbranch_scc1 K1_CS
  s_cmp_lt_u32 s2, 312
  s_cbranch_scc1 K1_RL
  s_sub_u32 s2, s2, 312
  s_and_b32 s24, s2, 7
  s_lshr_b32 s25, s2, 7
  s_lshl_b32 s25, s25, 3
  s_add_u32 s24, s24, s25
  s_cmp_ge_u32 s24, 33
  s_cbranch_scc1 K1_END
  s_lshr_b32 s25, s2, 3
  s_and_b32 s25, s25, 15
  s_lshl_b32 s2, s24, 4
  s_add_u32 s2, s2, s25
  s_mul_i32 s24, s24, 18432
  s_lshl_b32 s25, s25, 4
  s_add_u32 s25, s25, s24
  s_mov_b32 s12, s4
  s_mov_b32 s13, s5
  s_mov_b32 s14, 4194304
  s_mov_b32 s15, 0x20000
  s_mov_b32 s16, s8
  s_mov_b32 s17, s9
  s_mov_b32 s18, 2433024
  s_mov_b32 s19, 0x20000
  s_add_u32 s20, s8, 2433024
  s_addc_u32 s21, s9, 0
  s_mov_b32 s22, 2433024
  s_mov_b32 s23, 0x20000
  s_add_u32 s24, s25, 16896
  v_mov_b32 v40, 0
  v_cmp_gt_u32 vcc, 96, v0
  s_and_saveexec_b64 s[26:27], vcc
  v_mul_u32_u24 v3, 43691, v0
  v_lshrrev_b32 v3, 20, v3
  v_mul_u32_u24 v4, 24, v3
  v_sub_u32 v4, v0, v4
  v_mul_u32_u24 v3, 608256, v3
  v_lshrrev_b32 v5, 2, v4
  v_and_b32 v4, 3, v4
  v_lshl_add_u32 v3, v5, 8, v3
  v_lshl_add_u32 v3, v4, 2, v3
  buffer_store_dword v40, v3, s[20:23], s24 offen
  s_mov_b64 exec, s[26:27]
  s_cmp_gt_u32 s2, 512
  s_cbranch_scc1 K1_ZROW
  s_sub_u32 s28, 1024, s2
  s_add_u32 s29, 1024, s2
  s_sub_u32 s30, 2048, s2
  s_and_b32 s30, s30, 2047
  s_cmp_eq_u32 s3, 1
  s_cselect_b32 s31, s28, s2
  s_cmp_eq_u32 s3, 2
  s_cselect_b32 s31, s29, s31
  s_cmp_eq_u32 s3, 3
  s_cselect_b32 s31, s30, s31
  s_lshl_b32 s31, s31, 11
  v_lshlrev_b32 v3, 4, v1
  buffer_load_dwordx4 v[4:7], v3, s[12:15], s31 offen
  buffer_load_dwordx4 v[8:11], v3, s[12:15], s31 offen offset:1024
  s_waitcnt vmcnt(0)
  v_lshlrev_b32 v16, 16, v4
  v_and_b32 v17, 0xffff0000, v4
  v_lshlrev_b32 v18, 16, v5
  v_and_b32 v19, 0xffff0000, v5
  v_lshlrev_b32 v20, 16, v6
  v_and_b32 v21, 0xffff0000, v6
  v_lshlrev_b32 v22, 16, v7
  v_and_b32 v23, 0xffff0000, v7
  v_lshlrev_b32 v24, 16, v8
  v_and_b32 v25, 0xffff0000, v8
  v_lshlrev_b32 v26, 16, v9
  v_and_b32 v27, 0xffff0000, v9
  v_lshlrev_b32 v28, 16, v10
  v_and_b32 v29, 0xffff0000, v10
  v_lshlrev_b32 v30, 16, v11
  v_and_b32 v31, 0xffff0000, v11
  v_add_f32 v12, v16, v17
  v_add_f32 v12, v12, v18
  v_add_f32 v12, v12, v19
  v_add_f32 v12, v12, v20
  v_add_f32 v12, v12, v21
  v_add_f32 v12, v12, v22
  v_add_f32 v12, v12, v23
  v_add_f32 v12, v12, v24
  v_add_f32 v12, v12, v25
  v_add_f32 v12, v12, v26
  v_add_f32 v12, v12, v27
  v_add_f32 v12, v12, v28
  v_add_f32 v12, v12, v29
  v_add_f32 v12, v12, v30
  v_add_f32 v12, v12, v31
  s_nop 1
  v_add_f32_dpp v12, v12, v12 quad_perm:[1,0,3,2] row_mask:0xf bank_mask:0xf
  s_nop 1
  v_add_f32_dpp v12, v12, v12 quad_perm:[2,3,0,1] row_mask:0xf bank_mask:0xf
  s_nop 1
  v_add_f32_dpp v12, v12, v12 row_half_mirror row_mask:0xf bank_mask:0xf
  s_nop 1
  v_add_f32_dpp v12, v12, v12 row_mirror row_mask:0xf bank_mask:0xf
  s_nop 1
  v_readlane_b32 s32, v12, 0
  v_readlane_b32 s33, v12, 16
  v_readlane_b32 s34, v12, 32
  v_readlane_b32 s35, v12, 48
  s_nop 1
  v_mov_b32 v12, s32
  v_add_f32 v12, s33, v12
  v_add_f32 v12, s34, v12
  v_add_f32 v12, s35, v12
  v_mul_f32 v12, 0x3a800000, v12
  v_sub_f32 v16, v16, v12
  v_sub_f32 v17, v17, v12
  v_sub_f32 v18, v18, v12
  v_sub_f32 v19, v19, v12
  v_sub_f32 v20, v20, v12
  v_sub_f32 v21, v21, v12
  v_sub_f32 v22, v22, v12
  v_sub_f32 v23, v23, v12
  v_sub_f32 v24, v24, v12
  v_sub_f32 v25, v25, v12
  v_sub_f32 v26, v26, v12
  v_sub_f32 v27, v27, v12
  v_sub_f32 v28, v28, v12
  v_sub_f32 v29, v29, v12
  v_sub_f32 v30, v30, v12
  v_sub_f32 v31, v31, v12
  v_mul_f32 v13, v16, v16
  v_fmac_f32 v13, v17, v17
  v_fmac_f32 v13, v18, v18
  v_fmac_f32 v13, v19, v19
  v_fmac_f32 v13, v20, v20
  v_fmac_f32 v13, v21, v21
  v_fmac_f32 v13, v22, v22
  v_fmac_f32 v13, v23, v23
  v_fmac_f32 v13, v24, v24
  v_fmac_f32 v13, v25, v25
  v_fmac_f32 v13, v26, v26
  v_fmac_f32 v13, v27, v27
  v_fmac_f32 v13, v28, v28
  v_fmac_f32 v13, v29, v29
  v_fmac_f32 v13, v30, v30
  v_fmac_f32 v13, v31, v31
  s_nop 1
  v_add_f32_dpp v13, v13, v13 quad_perm:[1,0,3,2] row_mask:0xf bank_mask:0xf
  s_nop 1
  v_add_f32_dpp v13, v13, v13 quad_perm:[2,3,0,1] row_mask:0xf bank_mask:0xf
  s_nop 1
  v_add_f32_dpp v13, v13, v13 row_half_mirror row_mask:0xf bank_mask:0xf
  s_nop 1
  v_add_f32_dpp v13, v13, v13 row_mirror row_mask:0xf bank_mask:0xf
  s_nop 1
  v_readlane_b32 s32, v13, 0
  v_readlane_b32 s33, v13, 16
  v_readlane_b32 s34, v13, 32
  v_readlane_b32 s35, v13, 48
  s_nop 1
  v_mov_b32 v13, s32
  v_add_f32 v13, s33, v13
  v_add_f32 v13, s34, v13
  v_add_f32 v13, s35, v13
  v_mov_b32 v14, 0x3727c5ac
  v_fmac_f32 v14, 0x3a800000, v13
  v_rsq_f32 v14, v14
  s_nop 0
  v_mul_f32 v16, v16, v14
  v_mul_f32 v17, v17, v14
  v_mul_f32 v18, v18, v14
  v_mul_f32 v19, v19, v14
  v_mul_f32 v20, v20, v14
  v_mul_f32 v21, v21, v14
  v_mul_f32 v22, v22, v14
  v_mul_f32 v23, v23, v14
  v_mul_f32 v24, v24, v14
  v_mul_f32 v25, v25, v14
  v_mul_f32 v26, v26, v14
  v_mul_f32 v27, v27, v14
  v_mul_f32 v28, v28, v14
  v_mul_f32 v29, v29, v14
  v_mul_f32 v30, v30, v14
  v_mul_f32 v31, v31, v14
  s_mul_i32 s32, s3, 4112
  v_lshlrev_b32 v3, 5, v1
  v_add_u32 v3, s32, v3
  ds_write_b128 v3, v[16:19]
  ds_write_b128 v3, v[20:23] offset:16
  ds_write_b128 v3, v[24:27] offset:2048
  ds_write_b128 v3, v[28:31] offset:2064
  v_cmp_eq_u32 vcc, 0, v1
  s_and_saveexec_b64 s[26:27], vcc
  ds_write_b32 v3, v16 offset:4096
  s_mov_b64 exec, s[26:27]
  s_waitcnt lgkmcnt(0)
  s_barrier
  v_lshlrev_b32 v3, 3, v0
  v_sub_u32 v4, 4092, v3
  ds_read_b64 v[8:9], v3 offset:0
  ds_read2_b32 v[10:11], v4 offset0:0 offset1:1
  ds_read_b64 v[12:13], v3 offset:4112
  v_add_u32 v5, 4112, v4
  ds_read2_b32 v[14:15], v5 offset0:0 offset1:1
  ds_read_b64 v[16:17], v3 offset:8224
  v_add_u32 v5, 8224, v4
  ds_read2_b32 v[18:19], v5 offset0:0 offset1:1
  ds_read_b64 v[20:21], v3 offset:12336
  v_add_u32 v5, 12336, v4
  ds_read2_b32 v[22:23], v5 offset0:0 offset1:1
  v_mov_b32 v5, 2048
  ds_read_b32 v24, v5 offset:0
  ds_read_b32 v25, v5 offset:4112
  ds_read_b32 v26, v5 offset:8224
  ds_read_b32 v27, v5 offset:12336
  s_cmp_eq_u32 s2, 0
  s_cselect_b32 s33, 0.5, 1.0
  s_cmp_eq_u32 s2, 512
  s_cselect_b32 s33, 0.5, s33
  v_mov_b32 v6, s33
  v_mul_f32 v7, 0.5, v6
  v_cmp_eq_u32 vcc, 0, v0
  s_nop 1
  v_cndmask_b32 v7, v6, v7, vcc
  s_waitcnt lgkmcnt(0)
  v_add_f32 v28, v8, v20
  v_add_f32 v29, v12, v16
  v_sub_f32 v30, v8, v20
  v_sub_f32 v31, v12, v16
  v_add_f32 v32, v28, v29
  v_sub_f32 v33, v28, v29
  v_sub_f32 v34, v30, v31
  v_add_f32 v35, v30, v31
  v_add_f32 v28, v9, v21
  v_add_f32 v29, v13, v17
  v_sub_f32 v30, v9, v21
  v_sub_f32 v31, v13, v17
  v_add_f32 v36, v28, v29
  v_sub_f32 v37, v28, v29
  v_sub_f32 v38, v30, v31
  v_add_f32 v39, v30, v31
  v_add_f32 v28, v10, v22
  v_add_f32 v29, v14, v18
  v_sub_f32 v30, v10, v22
  v_sub_f32 v31, v14, v18
  v_add_f32 v40, v28, v29
  v_sub_f32 v41, v28, v29
  v_sub_f32 v42, v30, v31
  v_add_f32 v43, v30, v31
  v_add_f32 v28, v11, v23
  v_add_f32 v29, v15, v19
  v_sub_f32 v30, v11, v23
  v_sub_f32 v31, v15, v19
  v_add_f32 v44, v28, v29
  v_sub_f32 v45, v28, v29
  v_sub_f32 v46, v30, v31
  v_add_f32 v47, v30, v31
  v_add_f32 v28, v24, v27
  v_add_f32 v29, v25, v26
  v_sub_f32 v30, v24, v27
  v_sub_f32 v31, v25, v26
  v_add_f32 v48, v28, v29
  v_sub_f32 v49, v28, v29
  v_sub_f32 v50, v30, v31
  v_add_f32 v51, v30, v31
  v_add_f32 v32, v32, v44
  v_add_f32 v36, v36, v40
  v_mul_f32 v32, v32, v7
  v_mul_f32 v36, v36, v6
  v_cvt_pk_bf16_f32 v52, v32, v36
  v_add_f32 v33, v33, v45
  v_add_f32 v37, v37, v41
  v_mul_f32 v33, v33, v7
  v_mul_f32 v37, v37, v6
  v_cvt_pk_bf16_f32 v53, v33, v37
  v_sub_f32 v34, v34, v46
  v_sub_f32 v38, v38, v42
  v_mul_f32 v34, v34, v7
  v_mul_f32 v38, v38, v6
  v_cvt_pk_bf16_f32 v54, v34, v38
  v_sub_f32 v35, v35, v47
  v_sub_f32 v39, v39, v43
  v_mul_f32 v35, v35, v7
  v_mul_f32 v39, v39, v6
  v_cvt_pk_bf16_f32 v55, v35, v39
  v_lshrrev_b32 v3, 2, v0
  v_lshlrev_b32 v3, 8, v3
  v_and_b32 v4, 3, v0
  v_lshl_add_u32 v3, v4, 2, v3
  s_add_u32 s34, s25, 0
  buffer_store_dword v52, v3, s[16:19], s34 offen
  s_add_u32 s34, s25, 608256
  buffer_store_dword v53, v3, s[16:19], s34 offen
  s_add_u32 s34, s25, 1216512
  buffer_store_dword v54, v3, s[16:19], s34 offen
  s_add_u32 s34, s25, 1824768
  buffer_store_dword v55, v3, s[16:19], s34 offen
  v_cmp_gt_u32 vcc, 32, v0
  s_and_saveexec_b64 s[26:27], vcc
  v_cmp_eq_u32 vcc, 0, v0
  v_mul_f32 v48, v48, v6
  v_cvt_pk_bf16_f32 v56, v48, 0
  v_cndmask_b32 v56, 0, v56, vcc
  v_mul_f32 v49, v49, v6
  v_cvt_pk_bf16_f32 v57, v49, 0
  v_cndmask_b32 v57, 0, v57, vcc
  v_mov_b32 v58, 0
  v_mov_b32 v59, 0
  s_add_u32 s34, s25, 16384
  buffer_store_dword v56, v3, s[16:19], s34 offen
  s_add_u32 s34, s25, 624640
  buffer_store_dword v57, v3, s[16:19], s34 offen
  s_add_u32 s34, s25, 1232896
  buffer_store_dword v58, v3, s[16:19], s34 offen
  s_add_u32 s34, s25, 1841152
  buffer_store_dword v59, v3, s[16:19], s34 offen
  s_endpgm
K1_ZROW:
  v_lshrrev_b32 v3, 2, v0
  v_lshlrev_b32 v3, 8, v3
  v_and_b32 v4, 3, v0
  v_lshl_add_u32 v3, v4, 2, v3
  v_cmp_gt_u32 vcc, 32, v0
  s_and_saveexec_b64 s[26:27], vcc
  s_add_u32 s34, s25, 16384
  buffer_store_dword v40, v3, s[16:19], s34 offen
  s_add_u32 s34, s25, 624640
  buffer_store_dword v40, v3, s[16:19], s34 offen
  s_add_u32 s34, s25, 1232896
  buffer_store_dword v40, v3, s[16:19], s34 offen
  s_add_u32 s34, s25, 1841152
  buffer_store_dword v40, v3, s[16:19], s34 offen
  s_mov_b64 exec, s[26:27]
  s_add_u32 s34, s25, 0
  buffer_store_dword v40, v3, s[16:19], s34 offen
  s_add_u32 s34, s25, 608256
  buffer_store_dword v40, v3, s[16:19], s34 offen
  s_add_u32 s34, s25, 1216512
  buffer_store_dword v40, v3, s[16:19], s34 offen
  s_add_u32 s34, s25, 1824768
  buffer_store_dword v40, v3, s[16:19], s34 offen
  s_endpgm
K1_CS:
  s_mov_b32 s12, s6
  s_mov_b32 s13, s7
  s_mov_b32 s14, 7340032
  s_mov_b32 s15, 0x20000
  s_add_u32 s16, s8, 9699328
  s_addc_u32 s17, s9, 0
  s_mov_b32 s18, 229376
  s_mov_b32 s19, 0x20000
  s_mov_b32 s24, s2
  s_mul_i32 s25, s24, 9363
  s_lshr_b32 s25, s25, 16
  s_mul_i32 s26, s25, 7
  s_sub_u32 s26, s24, s26
  s_mul_i32 s27, s25, 458752
  s_lshl_b32 s28, s26, 10
  s_add_u32 s27, s27, s28
  v_lshlrev_b32 v3, 2, v0
  v_mov_b32 v4, 0
  v_mov_b32 v5, 0
  buffer_load_dword v8, v3, s[12:15], s27 offen
  s_add_u32 s27, s27, 7168
  buffer_load_dword v9, v3, s[12:15], s27 offen
  s_add_u32 s27, s27, 7168
  buffer_load_dword v10, v3, s[12:15], s27 offen
  s_add_u32 s27, s27, 7168
  buffer_load_dword v11, v3, s[12:15], s27 offen
  s_add_u32 s27, s27, 7168
  buffer_load_dword v12, v3, s[12:15], s27 offen
  s_add_u32 s27, s27, 7168
  buffer_load_dword v13, v3, s[12:15], s27 offen
  s_add_u32 s27, s27, 7168
  buffer_load_dword v14, v3, s[12:15], s27 offen
  s_add_u32 s27, s27, 7168
  buffer_load_dword v15, v3, s[12:15], s27 offen
  s_add_u32 s27, s27, 7168
  buffer_load_dword v16, v3, s[12:15], s27 offen
  s_add_u32 s27, s27, 7168
  buffer_load_dword v17, v3, s[12:15], s27 offen
  s_add_u32 s27, s27, 7168
  buffer_load_dword v18, v3, s[12:15], s27 offen
  s_add_u32 s27, s27, 7168
  buffer_load_dword v19, v3, s[12:15], s27 offen
  s_add_u32 s27, s27, 7168
  buffer_load_dword v20, v3, s[12:15], s27 offen
  s_add_u32 s27, s27, 7168
  buffer_load_dword v21, v3, s[12:15], s27 offen
  s_add_u32 s27, s27, 7168
  buffer_load_dword v22, v3, s[12:15], s27 offen
  s_add_u32 s27, s27, 7168
  buffer_load_dword v23, v3, s[12:15], s27 offen
  s_add_u32 s27, s27, 7168
  buffer_load_dword v24, v3, s[12:15], s27 offen
  s_add_u32 s27, s27, 7168
  buffer_load_dword v25, v3, s[12:15], s27 offen
  s_add_u32 s27, s27, 7168
  buffer_load_dword v26, v3, s[12:15], s27 offen
  s_add_u32 s27, s27, 7168
  buffer_load_dword v27, v3, s[12:15], s27 offen
  s_add_u32 s27, s27, 7168
  buffer_load_dword v28, v3, s[12:15], s27 offen
  s_add_u32 s27, s27, 7168
  buffer_load_dword v29, v3, s[12:15], s27 offen
  s_add_u32 s27, s27, 7168
  buffer_load_dword v30, v3, s[12:15], s27 offen
  s_add_u32 s27, s27, 7168
  buffer_load_dword v31, v3, s[12:15], s27 offen
  s_add_u32 s27, s27, 7168
  buffer_load_dword v32, v3, s[12:15], s27 offen
  s_add_u32 s27, s27, 7168
  buffer_load_dword v33, v3, s[12:15], s27 offen
  s_add_u32 s27, s27, 7168
  buffer_load_dword v34, v3, s[12:15], s27 offen
  s_add_u32 s27, s27, 7168
  buffer_load_dword v35, v3, s[12:15], s27 offen
  s_add_u32 s27, s27, 7168
  buffer_load_dword v36, v3, s[12:15], s27 offen
  s_add_u32 s27, s27, 7168
  buffer_load_dword v37, v3, s[12:15], s27 offen
  s_add_u32 s27, s27, 7168
  buffer_load_dword v38, v3, s[12:15], s27 offen
  s_add_u32 s27, s27, 7168
  buffer_load_dword v39, v3, s[12:15], s27 offen
  s_add_u32 s27, s27, 7168
  buffer_load_dword v40, v3, s[12:15], s27 offen
  s_add_u32 s27, s27, 7168
  buffer_load_dword v41, v3, s[12:15], s27 offen
  s_add_u32 s27, s27, 7168
  buffer_load_dword v42, v3, s[12:15], s27 offen
  s_add_u32 s27, s27, 7168
  buffer_load_dword v43, v3, s[12:15], s27 offen
  s_add_u32 s27, s27, 7168
  buffer_load_dword v44, v3, s[12:15], s27 offen
  s_add_u32 s27, s27, 7168
  buffer_load_dword v45, v3, s[12:15], s27 offen
  s_add_u32 s27, s27, 7168
  buffer_load_dword v46, v3, s[12:15], s27 offen
  s_add_u32 s27, s27, 7168
  buffer_load_dword v47, v3, s[12:15], s27 offen
  s_add_u32 s27, s27, 7168
  buffer_load_dword v48, v3, s[12:15], s27 offen
  s_add_u32 s27, s27, 7168
  buffer_load_dword v49, v3, s[12:15], s27 offen
  s_add_u32 s27, s27, 7168
  buffer_load_dword v50, v3, s[12:15], s27 offen
  s_add_u32 s27, s27, 7168
  buffer_load_dword v51, v3, s[12:15], s27 offen
  s_add_u32 s27, s27, 7168
  buffer_load_dword v52, v3, s[12:15], s27 offen
  s_add_u32 s27, s27, 7168
  buffer_load_dword v53, v3, s[12:15], s27 offen
  s_add_u32 s27, s27, 7168
  buffer_load_dword v54, v3, s[12:15], s27 offen
  s_add_u32 s27, s27, 7168
  buffer_load_dword v55, v3, s[12:15], s27 offen
  s_add_u32 s27, s27, 7168
  buffer_load_dword v56, v3, s[12:15], s27 offen
  s_add_u32 s27, s27, 7168
  buffer_load_dword v57, v3, s[12:15], s27 offen
  s_add_u32 s27, s27, 7168
  buffer_load_dword v58, v3, s[12:15], s27 offen
  s_add_u32 s27, s27, 7168
  buffer_load_dword v59, v3, s[12:15], s27 offen
  s_add_u32 s27, s27, 7168
  buffer_load_dword v60, v3, s[12:15], s27 offen
  s_add_u32 s27, s27, 7168
  buffer_load_dword v61, v3, s[12:15], s27 offen
  s_add_u32 s27, s27, 7168
  buffer_load_dword v62, v3, s[12:15], s27 offen
  s_add_u32 s27, s27, 7168
  buffer_load_dword v63, v3, s[12:15], s27 offen
  s_add_u32 s27, s27, 7168
  buffer_load_dword v64, v3, s[12:15], s27 offen
  s_add_u32 s27, s27, 7168
  buffer_load_dword v65, v3, s[12:15], s27 offen
  s_add_u32 s27, s27, 7168
  buffer_load_dword v66, v3, s[12:15], s27 offen
  s_add_u32 s27, s27, 7168
  buffer_load_dword v67, v3, s[12:15], s27 offen
  s_add_u32 s27, s27, 7168
  s_waitcnt vmcnt(56)
  buffer_load_dword v68, v3, s[12:15], s27 offen
  s_add_u32 s27, s27, 7168
  buffer_load_dword v69, v3, s[12:15], s27 offen
  s_add_u32 s27, s27, 7168
  buffer_load_dword v70, v3, s[12:15], s27 offen
  s_add_u32 s27, s27, 7168
  buffer_load_dword v71, v3, s[12:15], s27 offen
  s_add_u32 s27, s27, 7168
  s_waitcnt vmcnt(56)
  v_lshlrev_b32 v6, 16, v8
  v_and_b32 v7, 0xffff0000, v8
  v_add_f32 v4, v4, v6
  v_add_f32 v5, v5, v7
  s_waitcnt vmcnt(56)
  v_lshlrev_b32 v6, 16, v9
  v_and_b32 v7, 0xffff0000, v9
  v_add_f32 v4, v4, v6
  v_add_f32 v5, v5, v7
  s_waitcnt vmcnt(56)
  v_lshlrev_b32 v6, 16, v10
  v_and_b32 v7, 0xffff0000, v10
  v_add_f32 v4, v4, v6
  v_add_f32 v5, v5, v7
  s_waitcnt vmcnt(56)
  v_lshlrev_b32 v6, 16, v11
  v_and_b32 v7, 0xffff0000, v11
  v_add_f32 v4, v4, v6
  v_add_f32 v5, v5, v7
  s_waitcnt vmcnt(56)
  v_lshlrev_b32 v6, 16, v12
  v_and_b32 v7, 0xffff0000, v12
  v_add_f32 v4, v4, v6
  v_add_f32 v5, v5, v7
  s_waitcnt vmcnt(56)
  v_lshlrev_b32 v6, 16, v13
  v_and_b32 v7, 0xffff0000, v13
  v_add_f32 v4, v4, v6
  v_add_f32 v5, v5, v7
  s_waitcnt vmcnt(56)
  v_lshlrev_b32 v6, 16, v14
  v_and_b32 v7, 0xffff0000, v14
  v_add_f32 v4, v4, v6
  v_add_f32 v5, v5, v7
  s_waitcnt vmcnt(56)
  v_lshlrev_b32 v6, 16, v15
  v_and_b32 v7, 0xffff0000, v15
  v_add_f32 v4, v4, v6
  v_add_f32 v5, v5, v7
  s_waitcnt vmcnt(55)
  v_lshlrev_b32 v6, 16, v16
  v_and_b32 v7, 0xffff0000, v16
  v_add_f32 v4, v4, v6
  v_add_f32 v5, v5, v7
  s_waitcnt vmcnt(54)
  v_lshlrev_b32 v6, 16, v17
  v_and_b32 v7, 0xffff0000, v17
  v_add_f32 v4, v4, v6
  v_add_f32 v5, v5, v7
  s_waitcnt vmcnt(53)
  v_lshlrev_b32 v6, 16, v18
  v_and_b32 v7, 0xffff0000, v18
  v_add_f32 v4, v4, v6
  v_add_f32 v5, v5, v7
  s_waitcnt vmcnt(52)
  v_lshlrev_b32 v6, 16, v19
  v_and_b32 v7, 0xffff0000, v19
  v_add_f32 v4, v4, v6
  v_add_f32 v5, v5, v7
  s_waitcnt vmcnt(51)
  v_lshlrev_b32 v6, 16, v20
  v_and_b32 v7, 0xffff0000, v20
  v_add_f32 v4, v4, v6
  v_add_f32 v5, v5, v7
  s_waitcnt vmcnt(50)
  v_lshlrev_b32 v6, 16, v21
  v_and_b32 v7, 0xffff0000, v21
  v_add_f32 v4, v4, v6
  v_add_f32 v5, v5, v7
  s_waitcnt vmcnt(49)
  v_lshlrev_b32 v6, 16, v22
  v_and_b32 v7, 0xffff0000, v22
  v_add_f32 v4, v4, v6
  v_add_f32 v5, v5, v7
  s_waitcnt vmcnt(48)
  v_lshlrev_b32 v6, 16, v23
  v_and_b32 v7, 0xffff0000, v23
  v_add_f32 v4, v4, v6
  v_add_f32 v5, v5, v7
  s_waitcnt vmcnt(47)
  v_lshlrev_b32 v6, 16, v24
  v_and_b32 v7, 0xffff0000, v24
  v_add_f32 v4, v4, v6
  v_add_f32 v5, v5, v7
  s_waitcnt vmcnt(46)
  v_lshlrev_b32 v6, 16, v25
  v_and_b32 v7, 0xffff0000, v25
  v_add_f32 v4, v4, v6
  v_add_f32 v5, v5, v7
  s_waitcnt vmcnt(45)
  v_lshlrev_b32 v6, 16, v26
  v_and_b32 v7, 0xffff0000, v26
  v_add_f32 v4, v4, v6
  v_add_f32 v5, v5, v7
  s_waitcnt vmcnt(44)
  v_lshlrev_b32 v6, 16, v27
  v_and_b32 v7, 0xffff0000, v27
  v_add_f32 v4, v4, v6
  v_add_f32 v5, v5, v7
  s_waitcnt vmcnt(43)
  v_lshlrev_b32 v6, 16, v28
  v_and_b32 v7, 0xffff0000, v28
  v_add_f32 v4, v4, v6
  v_add_f32 v5, v5, v7
  s_waitcnt vmcnt(42)
  v_lshlrev_b32 v6, 16, v29
  v_and_b32 v7, 0xffff0000, v29
  v_add_f32 v4, v4, v6
  v_add_f32 v5, v5, v7
  s_waitcnt vmcnt(41)
  v_lshlrev_b32 v6, 16, v30
  v_and_b32 v7, 0xffff0000, v30
  v_add_f32 v4, v4, v6
  v_add_f32 v5, v5, v7
  s_waitcnt vmcnt(40)
  v_lshlrev_b32 v6, 16, v31
  v_and_b32 v7, 0xffff0000, v31
  v_add_f32 v4, v4, v6
  v_add_f32 v5, v5, v7
  s_waitcnt vmcnt(39)
  v_lshlrev_b32 v6, 16, v32
  v_and_b32 v7, 0xffff0000, v32
  v_add_f32 v4, v4, v6
  v_add_f32 v5, v5, v7
  s_waitcnt vmcnt(38)
  v_lshlrev_b32 v6, 16, v33
  v_and_b32 v7, 0xffff0000, v33
  v_add_f32 v4, v4, v6
  v_add_f32 v5, v5, v7
  s_waitcnt vmcnt(37)
  v_lshlrev_b32 v6, 16, v34
  v_and_b32 v7, 0xffff0000, v34
  v_add_f32 v4, v4, v6
  v_add_f32 v5, v5, v7
  s_waitcnt vmcnt(36)
  v_lshlrev_b32 v6, 16, v35
  v_and_b32 v7, 0xffff0000, v35
  v_add_f32 v4, v4, v6
  v_add_f32 v5, v5, v7
  s_waitcnt vmcnt(35)
  v_lshlrev_b32 v6, 16, v36
  v_and_b32 v7, 0xffff0000, v36
  v_add_f32 v4, v4, v6
  v_add_f32 v5, v5, v7
  s_waitcnt vmcnt(34)
  v_lshlrev_b32 v6, 16, v37
  v_and_b32 v7, 0xffff0000, v37
  v_add_f32 v4, v4, v6
  v_add_f32 v5, v5, v7
  s_waitcnt vmcnt(33)
  v_lshlrev_b32 v6, 16, v38
  v_and_b32 v7, 0xffff0000, v38
  v_add_f32 v4, v4, v6
  v_add_f32 v5, v5, v7
  s_waitcnt vmcnt(32)
  v_lshlrev_b32 v6, 16, v39
  v_and_b32 v7, 0xffff0000, v39
  v_add_f32 v4, v4, v6
  v_add_f32 v5, v5, v7
  s_waitcnt vmcnt(31)
  v_lshlrev_b32 v6, 16, v40
  v_and_b32 v7, 0xffff0000, v40
  v_add_f32 v4, v4, v6
  v_add_f32 v5, v5, v7
  s_waitcnt vmcnt(30)
  v_lshlrev_b32 v6, 16, v41
  v_and_b32 v7, 0xffff0000, v41
  v_add_f32 v4, v4, v6
  v_add_f32 v5, v5, v7
  s_waitcnt vmcnt(29)
  v_lshlrev_b32 v6, 16, v42
  v_and_b32 v7, 0xffff0000, v42
  v_add_f32 v4, v4, v6
  v_add_f32 v5, v5, v7
  s_waitcnt vmcnt(28)
  v_lshlrev_b32 v6, 16, v43
  v_and_b32 v7, 0xffff0000, v43
  v_add_f32 v4, v4, v6
  v_add_f32 v5, v5, v7
  s_waitcnt vmcnt(27)
  v_lshlrev_b32 v6, 16, v44
  v_and_b32 v7, 0xffff0000, v44
  v_add_f32 v4, v4, v6
  v_add_f32 v5, v5, v7
  s_waitcnt vmcnt(26)
  v_lshlrev_b32 v6, 16, v45
  v_and_b32 v7, 0xffff0000, v45
  v_add_f32 v4, v4, v6
  v_add_f32 v5, v5, v7
  s_waitcnt vmcnt(25)
  v_lshlrev_b32 v6, 16, v46
  v_and_b32 v7, 0xffff0000, v46
  v_add_f32 v4, v4, v6
  v_add_f32 v5, v5, v7
  s_waitcnt vmcnt(24)
  v_lshlrev_b32 v6, 16, v47
  v_and_b32 v7, 0xffff0000, v47
  v_add_f32 v4, v4, v6
  v_add_f32 v5, v5, v7
  s_waitcnt vmcnt(23)
  v_lshlrev_b32 v6, 16, v48
  v_and_b32 v7, 0xffff0000, v48
  v_add_f32 v4, v4, v6
  v_add_f32 v5, v5, v7
  s_waitcnt vmcnt(22)
  v_lshlrev_b32 v6, 16, v49
  v_and_b32 v7, 0xffff0000, v49
  v_add_f32 v4, v4, v6
  v_add_f32 v5, v5, v7
  s_waitcnt vmcnt(21)
  v_lshlrev_b32 v6, 16, v50
  v_and_b32 v7, 0xffff0000, v50
  v_add_f32 v4, v4, v6
  v_add_f32 v5, v5, v7
  s_waitcnt vmcnt(20)
  v_lshlrev_b32 v6, 16, v51
  v_and_b32 v7, 0xffff0000, v51
  v_add_f32 v4, v4, v6
  v_add_f32 v5, v5, v7
  s_waitcnt vmcnt(19)
  v_lshlrev_b32 v6, 16, v52
  v_and_b32 v7, 0xffff0000, v52
  v_add_f32 v4, v4, v6
  v_add_f32 v5, v5, v7
  s_waitcnt vmcnt(18)
  v_lshlrev_b32 v6, 16, v53
  v_and_b32 v7, 0xffff0000, v53
  v_add_f32 v4, v4, v6
  v_add_f32 v5, v5, v7
  s_waitcnt vmcnt(17)
  v_lshlrev_b32 v6, 16, v54
  v_and_b32 v7, 0xffff0000, v54
  v_add_f32 v4, v4, v6
  v_add_f32 v5, v5, v7
  s_waitcnt vmcnt(16)
  v_lshlrev_b32 v6, 16, v55
  v_and_b32 v7, 0xffff0000, v55
  v_add_f32 v4, v4, v6
  v_add_f32 v5, v5, v7
  s_waitcnt vmcnt(15)
  v_lshlrev_b32 v6, 16, v56
  v_and_b32 v7, 0xffff0000, v56
  v_add_f32 v4, v4, v6
  v_add_f32 v5, v5, v7
  s_waitcnt vmcnt(14)
  v_lshlrev_b32 v6, 16, v57
  v_and_b32 v7, 0xffff0000, v57
  v_add_f32 v4, v4, v6
  v_add_f32 v5, v5, v7
  s_waitcnt vmcnt(13)
  v_lshlrev_b32 v6, 16, v58
  v_and_b32 v7, 0xffff0000, v58
  v_add_f32 v4, v4, v6
  v_add_f32 v5, v5, v7
  s_waitcnt vmcnt(12)
  v_lshlrev_b32 v6, 16, v59
  v_and_b32 v7, 0xffff0000, v59
  v_add_f32 v4, v4, v6
  v_add_f32 v5, v5, v7
  s_waitcnt vmcnt(11)
  v_lshlrev_b32 v6, 16, v60
  v_and_b32 v7, 0xffff0000, v60
  v_add_f32 v4, v4, v6
  v_add_f32 v5, v5, v7
  s_waitcnt vmcnt(10)
  v_lshlrev_b32 v6, 16, v61
  v_and_b32 v7, 0xffff0000, v61
  v_add_f32 v4, v4, v6
  v_add_f32 v5, v5, v7
  s_waitcnt vmcnt(9)
  v_lshlrev_b32 v6, 16, v62
  v_and_b32 v7, 0xffff0000, v62
  v_add_f32 v4, v4, v6
  v_add_f32 v5, v5, v7
  s_waitcnt vmcnt(8)
  v_lshlrev_b32 v6, 16, v63
  v_and_b32 v7, 0xffff0000, v63
  v_add_f32 v4, v4, v6
  v_add_f32 v5, v5, v7
  s_waitcnt vmcnt(7)
  v_lshlrev_b32 v6, 16, v64
  v_and_b32 v7, 0xffff0000, v64
  v_add_f32 v4, v4, v6
  v_add_f32 v5, v5, v7
  s_waitcnt vmcnt(6)
  v_lshlrev_b32 v6, 16, v65
  v_and_b32 v7, 0xffff0000, v65
  v_add_f32 v4, v4, v6
  v_add_f32 v5, v5, v7
  s_waitcnt vmcnt(5)
  v_lshlrev_b32 v6, 16, v66
  v_and_b32 v7, 0xffff0000, v66
  v_add_f32 v4, v4, v6
  v_add_f32 v5, v5, v7
  s_waitcnt vmcnt(4)
  v_lshlrev_b32 v6, 16, v67
  v_and_b32 v7, 0xffff0000, v67
  v_add_f32 v4, v4, v6
  v_add_f32 v5, v5, v7
  s_waitcnt vmcnt(3)
  v_lshlrev_b32 v6, 16, v68
  v_and_b32 v7, 0xffff0000, v68
  v_add_f32 v4, v4, v6
  v_add_f32 v5, v5, v7
  s_waitcnt vmcnt(2)
  v_lshlrev_b32 v6, 16, v69
  v_and_b32 v7, 0xffff0000, v69
  v_add_f32 v4, v4, v6
  v_add_f32 v5, v5, v7
  s_waitcnt vmcnt(1)
  v_lshlrev_b32 v6, 16, v70
  v_and_b32 v7, 0xffff0000, v70
  v_add_f32 v4, v4, v6
  v_add_f32 v5, v5, v7
  s_waitcnt vmcnt(0)
  v_lshlrev_b32 v6, 16, v71
  v_and_b32 v7, 0xffff0000, v71
  v_add_f32 v4, v4, v6
  v_add_f32 v5, v5, v7
  s_mul_i32 s27, s25, 14336
  s_lshl_b32 s28, s26, 11
  s_add_u32 s27, s27, s28
  v_lshlrev_b32 v3, 3, v0
  buffer_store_dwordx2 v[4:5], v3, s[16:19], s27 offen
  s_endpgm
K1_RL:
  s_sub_u32 s24, s2, 112
  s_cmp_ge_u32 s24, 198
  s_cbranch_scc1 K1_END
  s_mul_i32 s25, s24, 1986
  s_lshr_b32 s25, s25, 16
  s_mul_i32 s26, s25, 33
  s_sub_u32 s26, s24, s26
  s_load_dwordx2 s[36:37], s[0:1], 8
  s_load_dwordx2 s[38:39], s[0:1], 16
  s_load_dwordx2 s[40:41], s[0:1], 24
  s_load_dwordx2 s[42:43], s[0:1], 32
  v_and_b32 v3, 15, v1
  v_lshrrev_b32 v4, 4, v1
  s_and_b32 s30, s25, 1
  s_lshl_b32 s30, s30, 12
  s_mov_b32 s31, 8388608
  s_cmp_lt_u32 s25, 2
  s_cselect_b32 s29, 11, 13
  s_cselect_b32 s30, 0, s30
  s_cselect_b32 s31, 2097152, s31
  s_lshl_b32 s32, s26, 4
  v_add_u32 v3, s32, v3
  v_lshlrev_b32 v3, s29, v3
  v_lshl_add_u32 v3, v4, 4, v3
  s_lshl_b32 s33, s3, 6
  s_add_u32 s30, s30, s33
  v_add_u32 v3, s30, v3
  s_mul_i32 s34, s25, 608256
  s_mul_i32 s35, s26, 18432
  s_add_u32 s34, s34, s35
  s_lshl_b32 s35, s3, 10
  s_add_u32 s34, s34, s35
  v_lshlrev_b32 v5, 4, v1
  s_waitcnt lgkmcnt(0)
  s_cmp_eq_u32 s25, 0
  s_cselect_b32 s12, s40, s42
  s_cselect_b32 s13, s41, s43
  s_cmp_lt_u32 s25, 2
  s_cbranch_scc1 K1_RLA
  s_cmp_lt_u32 s25, 4
  s_cselect_b32 s12, s36, s38
  s_cselect_b32 s13, s37, s39
K1_RLA:
  s_mov_b32 s14, s31
  s_mov_b32 s15, 0x20000
  s_add_u32 s16, s8, 27262976
  s_addc_u32 s17, s9, 0
  s_mov_b32 s18, 3649536
  s_mov_b32 s19, 0x20000
  buffer_load_dwordx4 v[8:11], v3, s[12:15], 0 offen offset:0
  buffer_load_dwordx4 v[12:15], v3, s[12:15], 0 offen offset:256
  buffer_load_dwordx4 v[16:19], v3, s[12:15], 0 offen offset:512
  buffer_load_dwordx4 v[20:23], v3, s[12:15], 0 offen offset:768
  s_cmp_ge_u32 s3, 2
  s_cbranch_scc1 K1_RLB
  buffer_load_dwordx4 v[24:27], v3, s[12:15], 0 offen offset:1024
  s_add_u32 s35, s34, 16384
  s_waitcnt vmcnt(0)
  buffer_store_dwordx4 v[24:27], v5, s[16:19], s35 offen
K1_RLB:
  s_waitcnt vmcnt(0)
  buffer_store_dwordx4 v[8:11], v5, s[16:19], s34 offen
  s_add_u32 s34, s34, 4096
  buffer_store_dwordx4 v[12:15], v5, s[16:19], s34 offen
  s_add_u32 s34, s34, 4096
  buffer_store_dwordx4 v[16:19], v5, s[16:19], s34 offen
  s_add_u32 s34, s34, 4096
  buffer_store_dwordx4 v[20:23], v5, s[16:19], s34 offen
  s_add_u32 s34, s34, 4096
K1_END:
  s_endpgm
.globl dft_hid_kernel
.p2align 8
.type dft_hid_kernel,@function
dft_hid_kernel:
  s_cmp_ge_u32 s2, 242
  s_cbranch_scc1 K2_END
  s_load_dwordx2 s[4:5], s[0:1], 24
  s_load_dwordx2 s[6:7], s[0:1], 32
  s_load_dwordx2 s[8:9], s[0:1], 80
  s_and_b32 s24, s2, 1
  s_lshr_b32 s27, s2, 1
  s_mul_i32 s25, s27, 5958
  s_lshr_b32 s25, s25, 16
  s_mul_i32 s26, s25, 11
  s_sub_u32 s26, s27, s26
  v_and_b32 v1, 63, v0
  v_lshrrev_b32 v2, 6, v0
  s_nop 0
  v_readfirstlane_b32 s3, v2
  v_and_b32 v3, 15, v1
  v_lshrrev_b32 v4, 4, v1
  s_nop 1
  s_and_b32 s28, s3, 1
  s_lshr_b32 s29, s3, 1
  s_waitcnt lgkmcnt(0)
  s_mov_b32 s12, s8
  s_mov_b32 s13, s9
  s_mov_b32 s14, 2433024
  s_mov_b32 s15, 0x20000
  s_add_u32 s16, s8, 27262976
  s_addc_u32 s17, s9, 0
  s_mov_b32 s18, 3649536
  s_mov_b32 s19, 0x20000
  s_add_u32 s20, s8, 2433024
  s_addc_u32 s21, s9, 0
  s_mov_b32 s22, 2433024
  s_mov_b32 s23, 0x20000
  s_lshl_b32 s30, s24, 1
  s_add_u32 s30, s30, s28
  s_mul_i32 s31, s30, 608256
  s_mul_i32 s32, s25, 55296
  s_add_u32 s32, s32, s31
  s_mul_i32 s33, s29, 9216
  s_add_u32 s32, s32, s33
  v_lshlrev_b32 v13, 4, v1
  v_add_u32 v10, s32, v13
  v_add_u32 v11, 18432, v10
  v_add_u32 v12, 36864, v10
  s_mov_b32 s34, s24
  s_mul_i32 s34, s34, 608256
  s_mul_i32 s35, s26, 55296
  s_add_u32 s34, s34, s35
  s_add_u32 s34, s34, s33
  v_add_u32 v13, s34, v13
  v_add_u32 v14, 18432, v13
  v_add_u32 v15, 36864, v13
  s_movk_i32 s76, 4096
  s_movk_i32 s77, 8192
  buffer_load_dwordx4 v[16:19], v10, s[12:15], 0 offen offset:0
  buffer_load_dwordx4 v[20:23], v11, s[12:15], 0 offen offset:0
  buffer_load_dwordx4 v[24:27], v12, s[12:15], 0 offen offset:0
  buffer_load_dwordx4 v[28:31], v13, s[16:19], 0 offen offset:0
  buffer_load_dwordx4 v[32:35], v14, s[16:19], 0 offen offset:0
  buffer_load_dwordx4 v[36:39], v15, s[16:19], 0 offen offset:0
  buffer_load_dwordx4 v[40:43], v10, s[12:15], 0 offen offset:1024
  buffer_load_dwordx4 v[44:47], v11, s[12:15], 0 offen offset:1024
  buffer_load_dwordx4 v[48:51], v12, s[12:15], 0 offen offset:1024
  buffer_load_dwordx4 v[52:55], v13, s[16:19], 0 offen offset:1024
  buffer_load_dwordx4 v[56:59], v14, s[16:19], 0 offen offset:1024
  buffer_load_dwordx4 v[60:63], v15, s[16:19], 0 offen offset:1024
  buffer_load_dwordx4 v[64:67], v10, s[12:15], 0 offen offset:2048
  buffer_load_dwordx4 v[68:71], v11, s[12:15], 0 offen offset:2048
  buffer_load_dwordx4 v[72:75], v12, s[12:15], 0 offen offset:2048
  buffer_load_dwordx4 v[76:79], v13, s[16:19], 0 offen offset:2048
  buffer_load_dwordx4 v[80:83], v14, s[16:19], 0 offen offset:2048
  buffer_load_dwordx4 v[84:87], v15, s[16:19], 0 offen offset:2048
  buffer_load_dwordx4 v[88:91], v10, s[12:15], 0 offen offset:3072
  buffer_load_dwordx4 v[92:95], v11, s[12:15], 0 offen offset:3072
  buffer_load_dwordx4 v[96:99], v12, s[12:15], 0 offen offset:3072
  buffer_load_dwordx4 v[100:103], v13, s[16:19], 0 offen offset:3072
  buffer_load_dwordx4 v[104:107], v14, s[16:19], 0 offen offset:3072
  buffer_load_dwordx4 v[108:111], v15, s[16:19], 0 offen offset:3072
  buffer_load_dwordx4 v[112:115], v10, s[12:15], s76 offen offset:0
  buffer_load_dwordx4 v[116:119], v11, s[12:15], s76 offen offset:0
  buffer_load_dwordx4 v[120:123], v12, s[12:15], s76 offen offset:0
  buffer_load_dwordx4 v[124:127], v13, s[16:19], s76 offen offset:0
  buffer_load_dwordx4 v[128:131], v14, s[16:19], s76 offen offset:0
  buffer_load_dwordx4 v[132:135], v15, s[16:19], s76 offen offset:0
  buffer_load_dwordx4 v[136:139], v10, s[12:15], s76 offen offset:1024
  buffer_load_dwordx4 v[140:143], v11, s[12:15], s76 offen offset:1024
  buffer_load_dwordx4 v[144:147], v12, s[12:15], s76 offen offset:1024
  buffer_load_dwordx4 v[148:151], v13, s[16:19], s76 offen offset:1024
  buffer_load_dwordx4 v[152:155], v14, s[16:19], s76 offen offset:1024
  buffer_load_dwordx4 v[156:159], v15, s[16:19], s76 offen offset:1024
  buffer_load_dwordx4 v[160:163], v10, s[12:15], s76 offen offset:2048
  buffer_load_dwordx4 v[164:167], v11, s[12:15], s76 offen offset:2048
  buffer_load_dwordx4 v[168:171], v12, s[12:15], s76 offen offset:2048
  buffer_load_dwordx4 v[172:175], v13, s[16:19], s76 offen offset:2048
  buffer_load_dwordx4 v[176:179], v14, s[16:19], s76 offen offset:2048
  buffer_load_dwordx4 v[180:183], v15, s[16:19], s76 offen offset:2048
  buffer_load_dwordx4 v[184:187], v10, s[12:15], s76 offen offset:3072
  buffer_load_dwordx4 v[188:191], v11, s[12:15], s76 offen offset:3072
  buffer_load_dwordx4 v[192:195], v12, s[12:15], s76 offen offset:3072
  buffer_load_dwordx4 v[196:199], v13, s[16:19], s76 offen offset:3072
  buffer_load_dwordx4 v[200:203], v14, s[16:19], s76 offen offset:3072
  buffer_load_dwordx4 v[204:207], v15, s[16:19], s76 offen offset:3072
  buffer_load_dwordx4 v[208:211], v10, s[12:15], s77 offen offset:0
  buffer_load_dwordx4 v[212:215], v11, s[12:15], s77 offen offset:0
  buffer_load_dwordx4 v[216:219], v12, s[12:15], s77 offen offset:0
  buffer_load_dwordx4 v[220:223], v13, s[16:19], s77 offen offset:0
  buffer_load_dwordx4 v[224:227], v14, s[16:19], s77 offen offset:0
  buffer_load_dwordx4 v[228:231], v15, s[16:19], s77 offen offset:0
  v_accvgpr_write_b32 a0, 0
  v_accvgpr_write_b32 a1, 0
  v_accvgpr_write_b32 a2, 0
  v_accvgpr_write_b32 a3, 0
  v_accvgpr_write_b32 a4, 0
  v_accvgpr_write_b32 a5, 0
  v_accvgpr_write_b32 a6, 0
  v_accvgpr_write_b32 a7, 0
  v_accvgpr_write_b32 a8, 0
  v_accvgpr_write_b32 a9, 0
  v_accvgpr_write_b32 a10, 0
  v_accvgpr_write_b32 a11, 0
  v_accvgpr_write_b32 a12, 0
  v_accvgpr_write_b32 a13, 0
  v_accvgpr_write_b32 a14, 0
  v_accvgpr_write_b32 a15, 0
  v_accvgpr_write_b32 a16, 0
  v_accvgpr_write_b32 a17, 0
  v_accvgpr_write_b32 a18, 0
  v_accvgpr_write_b32 a19, 0
  v_accvgpr_write_b32 a20, 0
  v_accvgpr_write_b32 a21, 0
  v_accvgpr_write_b32 a22, 0
  v_accvgpr_write_b32 a23, 0
  v_accvgpr_write_b32 a24, 0
  v_accvgpr_write_b32 a25, 0
  v_accvgpr_write_b32 a26, 0
  v_accvgpr_write_b32 a27, 0
  v_accvgpr_write_b32 a28, 0
  v_accvgpr_write_b32 a29, 0
  v_accvgpr_write_b32 a30, 0
  v_accvgpr_write_b32 a31, 0
  v_accvgpr_write_b32 a32, 0
  v_accvgpr_write_b32 a33, 0
  v_accvgpr_write_b32 a34, 0
  v_accvgpr_write_b32 a35, 0
  s_waitcnt vmcnt(48)
  v_mfma_f32_16x16x32_bf16 a[0:3], v[16:19], v[28:31], a[0:3]
  v_mfma_f32_16x16x32_bf16 a[4:7], v[16:19], v[32:35], a[4:7]
  v_mfma_f32_16x16x32_bf16 a[8:11], v[16:19], v[36:39], a[8:11]
  v_mfma_f32_16x16x32_bf16 a[12:15], v[20:23], v[28:31], a[12:15]
  v_mfma_f32_16x16x32_bf16 a[16:19], v[20:23], v[32:35], a[16:19]
  v_mfma_f32_16x16x32_bf16 a[20:23], v[20:23], v[36:39], a[20:23]
  v_mfma_f32_16x16x32_bf16 a[24:27], v[24:27], v[28:31], a[24:27]
  v_mfma_f32_16x16x32_bf16 a[28:31], v[24:27], v[32:35], a[28:31]
  v_mfma_f32_16x16x32_bf16 a[32:35], v[24:27], v[36:39], a[32:35]
  s_waitcnt vmcnt(42)
  v_mfma_f32_16x16x32_bf16 a[0:3], v[40:43], v[52:55], a[0:3]
  v_mfma_f32_16x16x32_bf16 a[4:7], v[40:43], v[56:59], a[4:7]
  v_mfma_f32_16x16x32_bf16 a[8:11], v[40:43], v[60:63], a[8:11]
  v_mfma_f32_16x16x32_bf16 a[12:15], v[44:47], v[52:55], a[12:15]
  v_mfma_f32_16x16x32_bf16 a[16:19], v[44:47], v[56:59], a[16:19]
  v_mfma_f32_16x16x32_bf16 a[20:23], v[44:47], v[60:63], a[20:23]
  v_mfma_f32_16x16x32_bf16 a[24:27], v[48:51], v[52:55], a[24:27]
  v_mfma_f32_16x16x32_bf16 a[28:31], v[48:51], v[56:59], a[28:31]
  v_mfma_f32_16x16x32_bf16 a[32:35], v[48:51], v[60:63], a[32:35]
  s_waitcnt vmcnt(36)
  v_mfma_f32_16x16x32_bf16 a[0:3], v[64:67], v[76:79], a[0:3]
  v_mfma_f32_16x16x32_bf16 a[4:7], v[64:67], v[80:83], a[4:7]
  v_mfma_f32_16x16x32_bf16 a[8:11], v[64:67], v[84:87], a[8:11]
  v_mfma_f32_16x16x32_bf16 a[12:15], v[68:71], v[76:79], a[12:15]
  v_mfma_f32_16x16x32_bf16 a[16:19], v[68:71], v[80:83], a[16:19]
  v_mfma_f32_16x16x32_bf16 a[20:23], v[68:71], v[84:87], a[20:23]
  v_mfma_f32_16x16x32_bf16 a[24:27], v[72:75], v[76:79], a[24:27]
  v_mfma_f32_16x16x32_bf16 a[28:31], v[72:75], v[80:83], a[28:31]
  v_mfma_f32_16x16x32_bf16 a[32:35], v[72:75], v[84:87], a[32:35]
  s_waitcnt vmcnt(30)
  v_mfma_f32_16x16x32_bf16 a[0:3], v[88:91], v[100:103], a[0:3]
  v_mfma_f32_16x16x32_bf16 a[4:7], v[88:91], v[104:107], a[4:7]
  v_mfma_f32_16x16x32_bf16 a[8:11], v[88:91], v[108:111], a[8:11]
  v_mfma_f32_16x16x32_bf16 a[12:15], v[92:95], v[100:103], a[12:15]
  v_mfma_f32_16x16x32_bf16 a[16:19], v[92:95], v[104:107], a[16:19]
  v_mfma_f32_16x16x32_bf16 a[20:23], v[92:95], v[108:111], a[20:23]
  v_mfma_f32_16x16x32_bf16 a[24:27], v[96:99], v[100:103], a[24:27]
  v_mfma_f32_16x16x32_bf16 a[28:31], v[96:99], v[104:107], a[28:31]
  v_mfma_f32_16x16x32_bf16 a[32:35], v[96:99], v[108:111], a[32:35]
  s_waitcnt vmcnt(24)
  v_mfma_f32_16x16x32_bf16 a[0:3], v[112:115], v[124:127], a[0:3]
  v_mfma_f32_16x16x32_bf16 a[4:7], v[112:115], v[128:131], a[4:7]
  v_mfma_f32_16x16x32_bf16 a[8:11], v[112:115], v[132:135], a[8:11]
  v_mfma_f32_16x16x32_bf16 a[12:15], v[116:119], v[124:127], a[12:15]
  v_mfma_f32_16x16x32_bf16 a[16:19], v[116:119], v[128:131], a[16:19]
  v_mfma_f32_16x16x32_bf16 a[20:23], v[116:119], v[132:135], a[20:23]
  v_mfma_f32_16x16x32_bf16 a[24:27], v[120:123], v[124:127], a[24:27]
  v_mfma_f32_16x16x32_bf16 a[28:31], v[120:123], v[128:131], a[28:31]
  v_mfma_f32_16x16x32_bf16 a[32:35], v[120:123], v[132:135], a[32:35]
  s_waitcnt vmcnt(18)
  v_mfma_f32_16x16x32_bf16 a[0:3], v[136:139], v[148:151], a[0:3]
  v_mfma_f32_16x16x32_bf16 a[4:7], v[136:139], v[152:155], a[4:7]
  v_mfma_f32_16x16x32_bf16 a[8:11], v[136:139], v[156:159], a[8:11]
  v_mfma_f32_16x16x32_bf16 a[12:15], v[140:143], v[148:151], a[12:15]
  v_mfma_f32_16x16x32_bf16 a[16:19], v[140:143], v[152:155], a[16:19]
  v_mfma_f32_16x16x32_bf16 a[20:23], v[140:143], v[156:159], a[20:23]
  v_mfma_f32_16x16x32_bf16 a[24:27], v[144:147], v[148:151], a[24:27]
  v_mfma_f32_16x16x32_bf16 a[28:31], v[144:147], v[152:155], a[28:31]
  v_mfma_f32_16x16x32_bf16 a[32:35], v[144:147], v[156:159], a[32:35]
  s_waitcnt vmcnt(12)
  v_mfma_f32_16x16x32_bf16 a[0:3], v[160:163], v[172:175], a[0:3]
  v_mfma_f32_16x16x32_bf16 a[4:7], v[160:163], v[176:179], a[4:7]
  v_mfma_f32_16x16x32_bf16 a[8:11], v[160:163], v[180:183], a[8:11]
  v_mfma_f32_16x16x32_bf16 a[12:15], v[164:167], v[172:175], a[12:15]
  v_mfma_f32_16x16x32_bf16 a[16:19], v[164:167], v[176:179], a[16:19]
  v_mfma_f32_16x16x32_bf16 a[20:23], v[164:167], v[180:183], a[20:23]
  v_mfma_f32_16x16x32_bf16 a[24:27], v[168:171], v[172:175], a[24:27]
  v_mfma_f32_16x16x32_bf16 a[28:31], v[168:171], v[176:179], a[28:31]
  v_mfma_f32_16x16x32_bf16 a[32:35], v[168:171], v[180:183], a[32:35]
  s_waitcnt vmcnt(6)
  v_mfma_f32_16x16x32_bf16 a[0:3], v[184:187], v[196:199], a[0:3]
  v_mfma_f32_16x16x32_bf16 a[4:7], v[184:187], v[200:203], a[4:7]
  v_mfma_f32_16x16x32_bf16 a[8:11], v[184:187], v[204:207], a[8:11]
  v_mfma_f32_16x16x32_bf16 a[12:15], v[188:191], v[196:199], a[12:15]
  v_mfma_f32_16x16x32_bf16 a[16:19], v[188:191], v[200:203], a[16:19]
  v_mfma_f32_16x16x32_bf16 a[20:23], v[188:191], v[204:207], a[20:23]
  v_mfma_f32_16x16x32_bf16 a[24:27], v[192:195], v[196:199], a[24:27]
  v_mfma_f32_16x16x32_bf16 a[28:31], v[192:195], v[200:203], a[28:31]
  v_mfma_f32_16x16x32_bf16 a[32:35], v[192:195], v[204:207], a[32:35]
  s_waitcnt vmcnt(0)
  v_mfma_f32_16x16x32_bf16 a[0:3], v[208:211], v[220:223], a[0:3]
  v_mfma_f32_16x16x32_bf16 a[4:7], v[208:211], v[224:227], a[4:7]
  v_mfma_f32_16x16x32_bf16 a[8:11], v[208:211], v[228:231], a[8:11]
  v_mfma_f32_16x16x32_bf16 a[12:15], v[212:215], v[220:223], a[12:15]
  v_mfma_f32_16x16x32_bf16 a[16:19], v[212:215], v[224:227], a[16:19]
  v_mfma_f32_16x16x32_bf16 a[20:23], v[212:215], v[228:231], a[20:23]
  v_mfma_f32_16x16x32_bf16 a[24:27], v[216:219], v[220:223], a[24:27]
  v_mfma_f32_16x16x32_bf16 a[28:31], v[216:219], v[224:227], a[28:31]
  v_mfma_f32_16x16x32_bf16 a[32:35], v[216:219], v[228:231], a[32:35]
  s_nop 7
  s_nop 1
  s_mul_i32 s35, s28, 9216
  v_lshlrev_b32 v5, 4, v1
  v_add_u32 v5, s35, v5
  v_accvgpr_read_b32 v16, a0
  v_accvgpr_read_b32 v17, a1
  v_accvgpr_read_b32 v18, a2
  v_accvgpr_read_b32 v19, a3
  v_accvgpr_read_b32 v20, a4
  v_accvgpr_read_b32 v21, a5
  v_accvgpr_read_b32 v22, a6
  v_accvgpr_read_b32 v23, a7
  v_accvgpr_read_b32 v24, a8
  v_accvgpr_read_b32 v25, a9
  v_accvgpr_read_b32 v26, a10
  v_accvgpr_read_b32 v27, a11
  v_accvgpr_read_b32 v28, a12
  v_accvgpr_read_b32 v29, a13
  v_accvgpr_read_b32 v30, a14
  v_accvgpr_read_b32 v31, a15
  v_accvgpr_read_b32 v32, a16
  v_accvgpr_read_b32 v33, a17
  v_accvgpr_read_b32 v34, a18
  v_accvgpr_read_b32 v35, a19
  v_accvgpr_read_b32 v36, a20
  v_accvgpr_read_b32 v37, a21
  v_accvgpr_read_b32 v38, a22
  v_accvgpr_read_b32 v39, a23
  v_accvgpr_read_b32 v40, a24
  v_accvgpr_read_b32 v41, a25
  v_accvgpr_read_b32 v42, a26
  v_accvgpr_read_b32 v43, a27
  v_accvgpr_read_b32 v44, a28
  v_accvgpr_read_b32 v45, a29
  v_accvgpr_read_b32 v46, a30
  v_accvgpr_read_b32 v47, a31
  v_accvgpr_read_b32 v48, a32
  v_accvgpr_read_b32 v49, a33
  v_accvgpr_read_b32 v50, a34
  v_accvgpr_read_b32 v51, a35
  s_cmp_eq_u32 s29, 0
  s_cbranch_scc1 K2_RD
  ds_write_b128 v5, v[16:19] offset:0
  ds_write_b128 v5, v[20:23] offset:1024
  ds_write_b128 v5, v[24:27] offset:2048
  ds_write_b128 v5, v[28:31] offset:3072
  ds_write_b128 v5, v[32:35] offset:4096
  ds_write_b128 v5, v[36:39] offset:5120
  ds_write_b128 v5, v[40:43] offset:6144
  ds_write_b128 v5, v[44:47] offset:7168
  ds_write_b128 v5, v[48:51] offset:8192
  s_waitcnt lgkmcnt(0)
  s_barrier
  s_endpgm
K2_RD:
  s_barrier
  ds_read_b128 v[56:59], v5 offset:0
  ds_read_b128 v[60:63], v5 offset:1024
  ds_read_b128 v[64:67], v5 offset:2048
  ds_read_b128 v[68:71], v5 offset:3072
  ds_read_b128 v[72:75], v5 offset:4096
  ds_read_b128 v[76:79], v5 offset:5120
  ds_read_b128 v[80:83], v5 offset:6144
  ds_read_b128 v[84:87], v5 offset:7168
  ds_read_b128 v[88:91], v5 offset:8192
  s_mul_i32 s34, s26, 55296
  s_add_u32 s34, s34, s31
  s_mul_i32 s35, s25, 1536
  s_add_u32 s34, s34, s35
  v_lshlrev_b32 v6, 4, v3
  v_lshrrev_b32 v7, 1, v4
  v_lshl_add_u32 v6, v7, 8, v6
  v_and_b32 v7, 1, v4
  v_lshl_add_u32 v6, v7, 3, v6
  v_add_u32 v6, s34, v6
  v_add_u32 v7, 18432, v6
  v_add_u32 v8, 36864, v6
  s_waitcnt lgkmcnt(0)
  v_add_f32 v16, v16, v56
  v_add_f32 v17, v17, v57
  v_add_f32 v18, v18, v58
  v_add_f32 v19, v19, v59
  v_cvt_pk_bf16_f32 v100, v16, v17
  v_cvt_pk_bf16_f32 v101, v18, v19
  buffer_store_dwordx2 v[100:101], v6, s[20:23], 0 offen offset:0
  v_add_f32 v20, v20, v60
  v_add_f32 v21, v21, v61
  v_add_f32 v22, v22, v62
  v_add_f32 v23, v23, v63
  v_cvt_pk_bf16_f32 v102, v20, v21
  v_cvt_pk_bf16_f32 v103, v22, v23
  buffer_store_dwordx2 v[102:103], v7, s[20:23], 0 offen offset:0
  v_add_f32 v24, v24, v64
  v_add_f32 v25, v25, v65
  v_add_f32 v26, v26, v66
  v_add_f32 v27, v27, v67
  v_cvt_pk_bf16_f32 v104, v24, v25
  v_cvt_pk_bf16_f32 v105, v26, v27
  buffer_store_dwordx2 v[104:105], v8, s[20:23], 0 offen offset:0
  v_add_f32 v28, v28, v68
  v_add_f32 v29, v29, v69
  v_add_f32 v30, v30, v70
  v_add_f32 v31, v31, v71
  v_cvt_pk_bf16_f32 v106, v28, v29
  v_cvt_pk_bf16_f32 v107, v30, v31
  buffer_store_dwordx2 v[106:107], v6, s[20:23], 0 offen offset:512
  v_add_f32 v32, v32, v72
  v_add_f32 v33, v33, v73
  v_add_f32 v34, v34, v74
  v_add_f32 v35, v35, v75
  v_cvt_pk_bf16_f32 v108, v32, v33
  v_cvt_pk_bf16_f32 v109, v34, v35
  buffer_store_dwordx2 v[108:109], v7, s[20:23], 0 offen offset:512
  v_add_f32 v36, v36, v76
  v_add_f32 v37, v37, v77
  v_add_f32 v38, v38, v78
  v_add_f32 v39, v39, v79
  v_cvt_pk_bf16_f32 v110, v36, v37
  v_cvt_pk_bf16_f32 v111, v38, v39
  buffer_store_dwordx2 v[110:111], v8, s[20:23], 0 offen offset:512
  v_add_f32 v40, v40, v80
  v_add_f32 v41, v41, v81
  v_add_f32 v42, v42, v82
  v_add_f32 v43, v43, v83
  v_cvt_pk_bf16_f32 v112, v40, v41
  v_cvt_pk_bf16_f32 v113, v42, v43
  buffer_store_dwordx2 v[112:113], v6, s[20:23], 0 offen offset:1024
  v_add_f32 v44, v44, v84
  v_add_f32 v45, v45, v85
  v_add_f32 v46, v46, v86
  v_add_f32 v47, v47, v87
  v_cvt_pk_bf16_f32 v114, v44, v45
  v_cvt_pk_bf16_f32 v115, v46, v47
  buffer_store_dwordx2 v[114:115], v7, s[20:23], 0 offen offset:1024
  v_add_f32 v48, v48, v88
  v_add_f32 v49, v49, v89
  v_add_f32 v50, v50, v90
  v_add_f32 v51, v51, v91
  v_cvt_pk_bf16_f32 v116, v48, v49
  v_cvt_pk_bf16_f32 v117, v50, v51
  buffer_store_dwordx2 v[116:117], v8, s[20:23], 0 offen offset:1024
K2_END:
  s_endpgm
.globl dft_seq_kernel
.p2align 8
.type dft_seq_kernel,@function
dft_seq_kernel:
  s_cmp_ge_u32 s2, 242
  s_cbranch_scc1 K3_END
  s_load_dwordx2 s[4:5], s[0:1], 8
  s_load_dwordx2 s[6:7], s[0:1], 16
  s_load_dwordx2 s[8:9], s[0:1], 80
  s_load_dwordx2 s[10:11], s[0:1], 0
  s_and_b32 s24, s2, 1
  s_lshr_b32 s27, s2, 1
  s_mul_i32 s25, s27, 5958
  s_lshr_b32 s25, s25, 16
  s_mul_i32 s26, s25, 11
  s_sub_u32 s26, s27, s26
  v_and_b32 v1, 63, v0
  v_lshrrev_b32 v2, 6, v0
  s_nop 0
  v_readfirstlane_b32 s3, v2
  v_and_b32 v3, 15, v1
  v_lshrrev_b32 v4, 4, v1
  s_nop 1
  s_and_b32 s28, s3, 1
  s_lshr_b32 s29, s3, 1
  s_waitcnt lgkmcnt(0)
  s_add_u32 s12, s8, 2433024
  s_addc_u32 s13, s9, 0
  s_mov_b32 s14, 2433024
  s_mov_b32 s15, 0x20000
  s_add_u32 s16, s8, 27262976
  s_addc_u32 s17, s9, 0
  s_mov_b32 s18, 3649536
  s_mov_b32 s19, 0x20000
  s_add_u32 s20, s8, 5242880
  s_addc_u32 s21, s9, 0
  s_mov_b32 s22, 4194304
  s_mov_b32 s23, 0x20000
  s_mov_b32 s36, s10
  s_mov_b32 s37, s11
  s_mov_b32 s38, 4194304
  s_mov_b32 s39, 0x20000
  s_add_u32 s40, s8, 9437184
  s_addc_u32 s41, s9, 0
  s_mov_b32 s42, 180224
  s_mov_b32 s43, 0x20000
  s_lshl_b32 s30, s28, 1
  s_add_u32 s30, s30, s24
  s_mul_i32 s31, s30, 608256
  s_mul_i32 s32, s26, 55296
  s_add_u32 s32, s32, s31
  s_mul_i32 s33, s29, 9216
  s_add_u32 s32, s32, s33
  v_lshlrev_b32 v13, 4, v1
  v_add_u32 v10, s32, v13
  v_add_u32 v11, 18432, v10
  v_add_u32 v12, 36864, v10
  s_add_u32 s34, s30, 2
  s_mul_i32 s34, s34, 608256
  s_mul_i32 s35, s25, 55296
  s_add_u32 s34, s34, s35
  s_add_u32 s34, s34, s33
  v_add_u32 v13, s34, v13
  v_add_u32 v14, 18432, v13
  v_add_u32 v15, 36864, v13
  s_add_u32 s47, s3, 0
  s_mul_i32 s44, s47, 43
  s_lshr_b32 s44, s44, 7
  s_mul_i32 s45, s44, 3
  s_sub_u32 s45, s47, s45
  s_lshl_b32 s46, s44, 6
  s_mul_i32 s56, s45, 3328
  s_sub_u32 s64, s56, s46
  s_add_u32 s64, s64, 176
  s_add_u32 s46, s46, s56
  s_lshl_b32 s44, s44, 4
  s_mul_i32 s56, s26, 48
  s_add_u32 s44, s44, s56
  s_lshl_b32 s45, s45, 4
  s_mul_i32 s56, s25, 48
  s_add_u32 s45, s45, s56
  s_lshl_b32 s45, s45, 1
  s_add_u32 s45, s45, s24
  s_add_u32 s51, s3, 4
  s_mul_i32 s48, s51, 43
  s_lshr_b32 s48, s48, 7
  s_mul_i32 s49, s48, 3
  s_sub_u32 s49, s51, s49
  s_lshl_b32 s50, s48, 6
  s_mul_i32 s56, s49, 3328
  s_sub_u32 s65, s56, s50
  s_add_u32 s65, s65, 176
  s_add_u32 s50, s50, s56
  s_lshl_b32 s48, s48, 4
  s_mul_i32 s56, s26, 48
  s_add_u32 s48, s48, s56
  s_lshl_b32 s49, s49, 4
  s_mul_i32 s56, s25, 48
  s_add_u32 s49, s49, s56
  s_lshl_b32 s49, s49, 1
  s_add_u32 s49, s49, s24
  s_add_u32 s55, s3, 8
  s_mul_i32 s52, s55, 43
  s_lshr_b32 s52, s52, 7
  s_mul_i32 s53, s52, 3
  s_sub_u32 s53, s55, s53
  s_lshl_b32 s54, s52, 6
  s_mul_i32 s56, s53, 3328
  s_sub_u32 s66, s56, s54
  s_add_u32 s66, s66, 176
  s_add_u32 s54, s54, s56
  s_lshl_b32 s52, s52, 4
  s_mul_i32 s56, s26, 48
  s_add_u32 s52, s52, s56
  s_lshl_b32 s53, s53, 4
  s_mul_i32 s56, s25, 48
  s_add_u32 s53, s53, s56
  s_lshl_b32 s53, s53, 1
  s_add_u32 s53, s53, s24
  s_movk_i32 s72, 1024
  s_movk_i32 s73, 1023
  s_movk_i32 s74, 512
  s_movk_i32 s75, 508
  s_mul_i32 s67, s25, 96
  s_add_u32 s67, s67, s24
  s_mul_i32 s68, s26, 48
  s_sub_u32 s69, 977, s68
  s_movk_i32 s76, 4096
  s_movk_i32 s77, 8192
  buffer_load_dwordx4 v[16:19], v10, s[12:15], 0 offen offset:0
  buffer_load_dwordx4 v[20:23], v11, s[12:15], 0 offen offset:0
  buffer_load_dwordx4 v[24:27], v12, s[12:15], 0 offen offset:0
  buffer_load_dwordx4 v[28:31], v13, s[16:19], 0 offen offset:0
  buffer_load_dwordx4 v[32:35], v14, s[16:19], 0 offen offset:0
  buffer_load_dwordx4 v[36:39], v15, s[16:19], 0 offen offset:0
  buffer_load_dwordx4 v[40:43], v10, s[12:15], 0 offen offset:1024
  buffer_load_dwordx4 v[44:47], v11, s[12:15], 0 offen offset:1024
  buffer_load_dwordx4 v[48:51], v12, s[12:15], 0 offen offset:1024
  buffer_load_dwordx4 v[52:55], v13, s[16:19], 0 offen offset:1024
  buffer_load_dwordx4 v[56:59], v14, s[16:19], 0 offen offset:1024
  buffer_load_dwordx4 v[60:63], v15, s[16:19], 0 offen offset:1024
  buffer_load_dwordx4 v[64:67], v10, s[12:15], 0 offen offset:2048
  buffer_load_dwordx4 v[68:71], v11, s[12:15], 0 offen offset:2048
  buffer_load_dwordx4 v[72:75], v12, s[12:15], 0 offen offset:2048
  buffer_load_dwordx4 v[76:79], v13, s[16:19], 0 offen offset:2048
  buffer_load_dwordx4 v[80:83], v14, s[16:19], 0 offen offset:2048
  buffer_load_dwordx4 v[84:87], v15, s[16:19], 0 offen offset:2048
  buffer_load_dwordx4 v[88:91], v10, s[12:15], 0 offen offset:3072
  buffer_load_dwordx4 v[92:95], v11, s[12:15], 0 offen offset:3072
  buffer_load_dwordx4 v[96:99], v12, s[12:15], 0 offen offset:3072
  buffer_load_dwordx4 v[100:103], v13, s[16:19], 0 offen offset:3072
  buffer_load_dwordx4 v[104:107], v14, s[16:19], 0 offen offset:3072
  buffer_load_dwordx4 v[108:111], v15, s[16:19], 0 offen offset:3072
  buffer_load_dwordx4 v[112:115], v10, s[12:15], s76 offen offset:0
  buffer_load_dwordx4 v[116:119], v11, s[12:15], s76 offen offset:0
  buffer_load_dwordx4 v[120:123], v12, s[12:15], s76 offen offset:0
  buffer_load_dwordx4 v[124:127], v13, s[16:19], s76 offen offset:0
  buffer_load_dwordx4 v[128:131], v14, s[16:19], s76 offen offset:0
  buffer_load_dwordx4 v[132:135], v15, s[16:19], s76 offen offset:0
  buffer_load_dwordx4 v[136:139], v10, s[12:15], s76 offen offset:1024
  buffer_load_dwordx4 v[140:143], v11, s[12:15], s76 offen offset:1024
  buffer_load_dwordx4 v[144:147], v12, s[12:15], s76 offen offset:1024
  buffer_load_dwordx4 v[148:151], v13, s[16:19], s76 offen offset:1024
  buffer_load_dwordx4 v[152:155], v14, s[16:19], s76 offen offset:1024
  buffer_load_dwordx4 v[156:159], v15, s[16:19], s76 offen offset:1024
  buffer_load_dwordx4 v[160:163], v10, s[12:15], s76 offen offset:2048
  buffer_load_dwordx4 v[164:167], v11, s[12:15], s76 offen offset:2048
  buffer_load_dwordx4 v[168:171], v12, s[12:15], s76 offen offset:2048
  buffer_load_dwordx4 v[172:175], v13, s[16:19], s76 offen offset:2048
  buffer_load_dwordx4 v[176:179], v14, s[16:19], s76 offen offset:2048
  buffer_load_dwordx4 v[180:183], v15, s[16:19], s76 offen offset:2048
  buffer_load_dwordx4 v[184:187], v10, s[12:15], s76 offen offset:3072
  buffer_load_dwordx4 v[188:191], v11, s[12:15], s76 offen offset:3072
  buffer_load_dwordx4 v[192:195], v12, s[12:15], s76 offen offset:3072
  buffer_load_dwordx4 v[196:199], v13, s[16:19], s76 offen offset:3072
  buffer_load_dwordx4 v[200:203], v14, s[16:19], s76 offen offset:3072
  buffer_load_dwordx4 v[204:207], v15, s[16:19], s76 offen offset:3072
  buffer_load_dwordx4 v[208:211], v10, s[12:15], s77 offen offset:0
  buffer_load_dwordx4 v[212:215], v11, s[12:15], s77 offen offset:0
  buffer_load_dwordx4 v[216:219], v12, s[12:15], s77 offen offset:0
  buffer_load_dwordx4 v[220:223], v13, s[16:19], s77 offen offset:0
  buffer_load_dwordx4 v[224:227], v14, s[16:19], s77 offen offset:0
  buffer_load_dwordx4 v[228:231], v15, s[16:19], s77 offen offset:0
  v_add_u32 v5, 0, v0
  v_mul_u32_u24 v6, 10923, v5
  v_lshrrev_b32 v6, 16, v6
  v_mul_u32_u24 v7, 6, v6
  v_sub_u32 v7, v5, v7
  v_mul_u32_u24 v8, 1366, v6
  v_lshrrev_b32 v8, 16, v8
  v_mul_u32_u24 v9, 48, v8
  v_sub_u32 v9, v6, v9
  v_lshl_add_u32 v9, v9, 1, s67
  v_cmp_lt_u32 s[60:61], 1, v8
  v_sub_u32 v2, 2048, v9
  v_and_b32 v5, 1, v8
  v_cmp_eq_u32 s[62:63], 1, v5
  v_cndmask_b32 v2, v9, v2, s[60:61]
  v_lshlrev_b32 v2, 11, v2
  v_mov_b32 v5, s68
  v_mov_b32 v252, s69
  v_cndmask_b32 v5, v5, v252, s[62:63]
  v_lshl_add_u32 v5, v7, 3, v5
  v_lshl_add_u32 v2, v5, 1, v2
  v_mul_u32_u24 v232, 208, v6
  v_lshl_add_u32 v232, v7, 5, v232
  v_add_u32 v232, 46080, v232
  v_mul_u32_u24 v233, 48, v8
  v_sub_u32 v233, v6, v233
  v_lshrrev_b32 v234, 1, v8
  v_mul_u32_u24 v234, 48, v234
  v_add_u32 v233, v233, v234
  v_mul_u32_u24 v233, 96, v233
  v_and_b32 v234, 1, v8
  v_mul_u32_u24 v234, 6, v234
  v_add_u32 v234, v234, v7
  v_lshl_add_u32 v233, v234, 3, v233
  v_add_u32 v233, 36864, v233
  v_cmp_ge_u32 s[58:59], s72, v9
  v_cmp_ge_u32 vcc, s73, v9
  v_cmp_lt_u32 s[56:57], 0, v9
  s_and_b64 vcc, vcc, s[56:57]
  s_and_b64 vcc, vcc, s[60:61]
  s_andn2_b64 s[58:59], s[58:59], s[60:61]
  s_or_b64 s[58:59], s[58:59], vcc
  v_sub_u32 v234, 513, v5
  v_med3_i32 v234, v234, 0, 8
  v_sub_u32 v235, 1024, v5
  v_med3_i32 v235, v235, 0, 8
  v_cndmask_b32 v235, v234, v235, s[62:63]
  v_cndmask_b32 v234, 0, v234, s[62:63]
  v_sub_u32 v235, v235, v234
  v_cndmask_b32 v235, 0, v235, s[58:59]
  v_accvgpr_write_b32 a36, v2
  v_accvgpr_write_b32 a37, v232
  v_accvgpr_write_b32 a38, v233
  v_accvgpr_write_b32 a39, v234
  v_accvgpr_write_b32 a40, v235
  v_add_u32 v5, 256, v0
  v_mul_u32_u24 v6, 10923, v5
  v_lshrrev_b32 v6, 16, v6
  v_mul_u32_u24 v7, 6, v6
  v_sub_u32 v7, v5, v7
  v_mul_u32_u24 v8, 1366, v6
  v_lshrrev_b32 v8, 16, v8
  v_mul_u32_u24 v9, 48, v8
  v_sub_u32 v9, v6, v9
  v_lshl_add_u32 v9, v9, 1, s67
  v_cmp_lt_u32 s[60:61], 1, v8
  v_sub_u32 v2, 2048, v9
  v_and_b32 v5, 1, v8
  v_cmp_eq_u32 s[62:63], 1, v5
  v_cndmask_b32 v2, v9, v2, s[60:61]
  v_lshlrev_b32 v2, 11, v2
  v_mov_b32 v5, s68
  v_mov_b32 v252, s69
  v_cndmask_b32 v5, v5, v252, s[62:63]
  v_lshl_add_u32 v5, v7, 3, v5
  v_lshl_add_u32 v2, v5, 1, v2
  v_mul_u32_u24 v232, 208, v6
  v_lshl_add_u32 v232, v7, 5, v232
  v_add_u32 v232, 46080, v232
  v_mul_u32_u24 v233, 48, v8
  v_sub_u32 v233, v6, v233
  v_lshrrev_b32 v234, 1, v8
  v_mul_u32_u24 v234, 48, v234
  v_add_u32 v233, v233, v234
  v_mul_u32_u24 v233, 96, v233
  v_and_b32 v234, 1, v8
  v_mul_u32_u24 v234, 6, v234
  v_add_u32 v234, v234, v7
  v_lshl_add_u32 v233, v234, 3, v233
  v_add_u32 v233, 36864, v233
  v_cmp_ge_u32 s[58:59], s72, v9
  v_cmp_ge_u32 vcc, s73, v9
  v_cmp_lt_u32 s[56:57], 0, v9
  s_and_b64 vcc, vcc, s[56:57]
  s_and_b64 vcc, vcc, s[60:61]
  s_andn2_b64 s[58:59], s[58:59], s[60:61]
  s_or_b64 s[58:59], s[58:59], vcc
  v_sub_u32 v234, 513, v5
  v_med3_i32 v234, v234, 0, 8
  v_sub_u32 v235, 1024, v5
  v_med3_i32 v235, v235, 0, 8
  v_cndmask_b32 v235, v234, v235, s[62:63]
  v_cndmask_b32 v234, 0, v234, s[62:63]
  v_sub_u32 v235, v235, v234
  v_cndmask_b32 v235, 0, v235, s[58:59]
  v_accvgpr_write_b32 a41, v2
  v_accvgpr_write_b32 a42, v232
  v_accvgpr_write_b32 a43, v233
  v_accvgpr_write_b32 a44, v234
  v_accvgpr_write_b32 a45, v235
  v_add_u32 v5, 512, v0
  v_mul_u32_u24 v6, 10923, v5
  v_lshrrev_b32 v6, 16, v6
  v_mul_u32_u24 v7, 6, v6
  v_sub_u32 v7, v5, v7
  v_mul_u32_u24 v8, 1366, v6
  v_lshrrev_b32 v8, 16, v8
  v_mul_u32_u24 v9, 48, v8
  v_sub_u32 v9, v6, v9
  v_lshl_add_u32 v9, v9, 1, s67
  v_cmp_lt_u32 s[60:61], 1, v8
  v_sub_u32 v2, 2048, v9
  v_and_b32 v5, 1, v8
  v_cmp_eq_u32 s[62:63], 1, v5
  v_cndmask_b32 v2, v9, v2, s[60:61]
  v_lshlrev_b32 v2, 11, v2
  v_mov_b32 v5, s68
  v_mov_b32 v252, s69
  v_cndmask_b32 v5, v5, v252, s[62:63]
  v_lshl_add_u32 v5, v7, 3, v5
  v_lshl_add_u32 v2, v5, 1, v2
  v_mul_u32_u24 v232, 208, v6
  v_lshl_add_u32 v232, v7, 5, v232
  v_add_u32 v232, 46080, v232
  v_mul_u32_u24 v233, 48, v8
  v_sub_u32 v233, v6, v233
  v_lshrrev_b32 v234, 1, v8
  v_mul_u32_u24 v234, 48, v234
  v_add_u32 v233, v233, v234
  v_mul_u32_u24 v233, 96, v233
  v_and_b32 v234, 1, v8
  v_mul_u32_u24 v234, 6, v234
  v_add_u32 v234, v234, v7
  v_lshl_add_u32 v233, v234, 3, v233
  v_add_u32 v233, 36864, v233
  v_cmp_ge_u32 s[58:59], s72, v9
  v_cmp_ge_u32 vcc, s73, v9
  v_cmp_lt_u32 s[56:57], 0, v9
  s_and_b64 vcc, vcc, s[56:57]
  s_and_b64 vcc, vcc, s[60:61]
  s_andn2_b64 s[58:59], s[58:59], s[60:61]
  s_or_b64 s[58:59], s[58:59], vcc
  v_sub_u32 v234, 513, v5
  v_med3_i32 v234, v234, 0, 8
  v_sub_u32 v235, 1024, v5
  v_med3_i32 v235, v235, 0, 8
  v_cndmask_b32 v235, v234, v235, s[62:63]
  v_cndmask_b32 v234, 0, v234, s[62:63]
  v_sub_u32 v235, v235, v234
  v_cndmask_b32 v235, 0, v235, s[58:59]
  v_accvgpr_write_b32 a46, v2
  v_accvgpr_write_b32 a47, v232
  v_accvgpr_write_b32 a48, v233
  v_accvgpr_write_b32 a49, v234
  v_accvgpr_write_b32 a50, v235
  v_add_u32 v5, 768, v0
  v_mul_u32_u24 v6, 10923, v5
  v_lshrrev_b32 v6, 16, v6
  v_mul_u32_u24 v7, 6, v6
  v_sub_u32 v7, v5, v7
  v_mul_u32_u24 v8, 1366, v6
  v_lshrrev_b32 v8, 16, v8
  v_mul_u32_u24 v9, 48, v8
  v_sub_u32 v9, v6, v9
  v_lshl_add_u32 v9, v9, 1, s67
  v_cmp_lt_u32 s[60:61], 1, v8
  v_sub_u32 v2, 2048, v9
  v_and_b32 v5, 1, v8
  v_cmp_eq_u32 s[62:63], 1, v5
  v_cndmask_b32 v2, v9, v2, s[60:61]
  v_lshlrev_b32 v2, 11, v2
  v_mov_b32 v5, s68
  v_mov_b32 v252, s69
  v_cndmask_b32 v5, v5, v252, s[62:63]
  v_lshl_add_u32 v5, v7, 3, v5
  v_lshl_add_u32 v2, v5, 1, v2
  v_mul_u32_u24 v232, 208, v6
  v_lshl_add_u32 v232, v7, 5, v232
  v_add_u32 v232, 46080, v232
  v_mul_u32_u24 v233, 48, v8
  v_sub_u32 v233, v6, v233
  v_lshrrev_b32 v234, 1, v8
  v_mul_u32_u24 v234, 48, v234
  v_add_u32 v233, v233, v234
  v_mul_u32_u24 v233, 96, v233
  v_and_b32 v234, 1, v8
  v_mul_u32_u24 v234, 6, v234
  v_add_u32 v234, v234, v7
  v_lshl_add_u32 v233, v234, 3, v233
  v_add_u32 v233, 36864, v233
  v_cmp_ge_u32 s[58:59], s72, v9
  v_cmp_ge_u32 vcc, s73, v9
  v_cmp_lt_u32 s[56:57], 0, v9
  s_and_b64 vcc, vcc, s[56:57]
  s_and_b64 vcc, vcc, s[60:61]
  s_andn2_b64 s[58:59], s[58:59], s[60:61]
  s_or_b64 s[58:59], s[58:59], vcc
  v_sub_u32 v234, 513, v5
  v_med3_i32 v234, v234, 0, 8
  v_sub_u32 v235, 1024, v5
  v_med3_i32 v235, v235, 0, 8
  v_cndmask_b32 v235, v234, v235, s[62:63]
  v_cndmask_b32 v234, 0, v234, s[62:63]
  v_sub_u32 v235, v235, v234
  v_cndmask_b32 v235, 0, v235, s[58:59]
  v_accvgpr_write_b32 a51, v2
  v_accvgpr_write_b32 a52, v232
  v_accvgpr_write_b32 a53, v233
  v_accvgpr_write_b32 a54, v234
  v_accvgpr_write_b32 a55, v235
  v_add_u32 v5, 1024, v0
  v_mul_u32_u24 v6, 10923, v5
  v_lshrrev_b32 v6, 16, v6
  v_mul_u32_u24 v7, 6, v6
  v_sub_u32 v7, v5, v7
  v_mul_u32_u24 v8, 1366, v6
  v_lshrrev_b32 v8, 16, v8
  v_mul_u32_u24 v9, 48, v8
  v_sub_u32 v9, v6, v9
  v_lshl_add_u32 v9, v9, 1, s67
  v_cmp_lt_u32 s[60:61], 1, v8
  v_sub_u32 v2, 2048, v9
  v_and_b32 v5, 1, v8
  v_cmp_eq_u32 s[62:63], 1, v5
  v_cndmask_b32 v2, v9, v2, s[60:61]
  v_lshlrev_b32 v2, 11, v2
  v_mov_b32 v5, s68
  v_mov_b32 v252, s69
  v_cndmask_b32 v5, v5, v252, s[62:63]
  v_lshl_add_u32 v5, v7, 3, v5
  v_lshl_add_u32 v2, v5, 1, v2
  v_mul_u32_u24 v232, 208, v6
  v_lshl_add_u32 v232, v7, 5, v232
  v_add_u32 v232, 46080, v232
  v_mul_u32_u24 v233, 48, v8
  v_sub_u32 v233, v6, v233
  v_lshrrev_b32 v234, 1, v8
  v_mul_u32_u24 v234, 48, v234
  v_add_u32 v233, v233, v234
  v_mul_u32_u24 v233, 96, v233
  v_and_b32 v234, 1, v8
  v_mul_u32_u24 v234, 6, v234
  v_add_u32 v234, v234, v7
  v_lshl_add_u32 v233, v234, 3, v233
  v_add_u32 v233, 36864, v233
  v_cmp_ge_u32 s[58:59], s72, v9
  v_cmp_ge_u32 vcc, s73, v9
  v_cmp_lt_u32 s[56:57], 0, v9
  s_and_b64 vcc, vcc, s[56:57]
  s_and_b64 vcc, vcc, s[60:61]
  s_andn2_b64 s[58:59], s[58:59], s[60:61]
  s_or_b64 s[58:59], s[58:59], vcc
  v_sub_u32 v234, 513, v5
  v_med3_i32 v234, v234, 0, 8
  v_sub_u32 v235, 1024, v5
  v_med3_i32 v235, v235, 0, 8
  v_cndmask_b32 v235, v234, v235, s[62:63]
  v_cndmask_b32 v234, 0, v234, s[62:63]
  v_sub_u32 v235, v235, v234
  v_cndmask_b32 v235, 0, v235, s[58:59]
  v_accvgpr_write_b32 a56, v2
  v_accvgpr_write_b32 a57, v232
  v_accvgpr_write_b32 a58, v233
  v_accvgpr_write_b32 a59, v234
  v_accvgpr_write_b32 a60, v235
  v_accvgpr_write_b32 a0, 0
  v_accvgpr_write_b32 a1, 0
  v_accvgpr_write_b32 a2, 0
  v_accvgpr_write_b32 a3, 0
  v_accvgpr_write_b32 a4, 0
  v_accvgpr_write_b32 a5, 0
  v_accvgpr_write_b32 a6, 0
  v_accvgpr_write_b32 a7, 0
  v_accvgpr_write_b32 a8, 0
  v_accvgpr_write_b32 a9, 0
  v_accvgpr_write_b32 a10, 0
  v_accvgpr_write_b32 a11, 0
  v_accvgpr_write_b32 a12, 0
  v_accvgpr_write_b32 a13, 0
  v_accvgpr_write_b32 a14, 0
  v_accvgpr_write_b32 a15, 0
  v_accvgpr_write_b32 a16, 0
  v_accvgpr_write_b32 a17, 0
  v_accvgpr_write_b32 a18, 0
  v_accvgpr_write_b32 a19, 0
  v_accvgpr_write_b32 a20, 0
  v_accvgpr_write_b32 a21, 0
  v_accvgpr_write_b32 a22, 0
  v_accvgpr_write_b32 a23, 0
  v_accvgpr_write_b32 a24, 0
  v_accvgpr_write_b32 a25, 0
  v_accvgpr_write_b32 a26, 0
  v_accvgpr_write_b32 a27, 0
  v_accvgpr_write_b32 a28, 0
  v_accvgpr_write_b32 a29, 0
  v_accvgpr_write_b32 a30, 0
  v_accvgpr_write_b32 a31, 0
  v_accvgpr_write_b32 a32, 0
  v_accvgpr_write_b32 a33, 0
  v_accvgpr_write_b32 a34, 0
  v_accvgpr_write_b32 a35, 0
  s_waitcnt vmcnt(48)
  v_mfma_f32_16x16x32_bf16 a[0:3], v[16:19], v[28:31], a[0:3]
  v_mfma_f32_16x16x32_bf16 a[4:7], v[16:19], v[32:35], a[4:7]
  v_mfma_f32_16x16x32_bf16 a[8:11], v[16:19], v[36:39], a[8:11]
  v_mfma_f32_16x16x32_bf16 a[12:15], v[20:23], v[28:31], a[12:15]
  v_mfma_f32_16x16x32_bf16 a[16:19], v[20:23], v[32:35], a[16:19]
  v_mfma_f32_16x16x32_bf16 a[20:23], v[20:23], v[36:39], a[20:23]
  v_mfma_f32_16x16x32_bf16 a[24:27], v[24:27], v[28:31], a[24:27]
  v_mfma_f32_16x16x32_bf16 a[28:31], v[24:27], v[32:35], a[28:31]
  v_mfma_f32_16x16x32_bf16 a[32:35], v[24:27], v[36:39], a[32:35]
  s_waitcnt vmcnt(42)
  v_mfma_f32_16x16x32_bf16 a[0:3], v[40:43], v[52:55], a[0:3]
  v_mfma_f32_16x16x32_bf16 a[4:7], v[40:43], v[56:59], a[4:7]
  v_mfma_f32_16x16x32_bf16 a[8:11], v[40:43], v[60:63], a[8:11]
  v_mfma_f32_16x16x32_bf16 a[12:15], v[44:47], v[52:55], a[12:15]
  v_mfma_f32_16x16x32_bf16 a[16:19], v[44:47], v[56:59], a[16:19]
  v_mfma_f32_16x16x32_bf16 a[20:23], v[44:47], v[60:63], a[20:23]
  v_mfma_f32_16x16x32_bf16 a[24:27], v[48:51], v[52:55], a[24:27]
  v_mfma_f32_16x16x32_bf16 a[28:31], v[48:51], v[56:59], a[28:31]
  v_mfma_f32_16x16x32_bf16 a[32:35], v[48:51], v[60:63], a[32:35]
  s_waitcnt vmcnt(36)
  v_mfma_f32_16x16x32_bf16 a[0:3], v[64:67], v[76:79], a[0:3]
  v_mfma_f32_16x16x32_bf16 a[4:7], v[64:67], v[80:83], a[4:7]
  v_mfma_f32_16x16x32_bf16 a[8:11], v[64:67], v[84:87], a[8:11]
  v_mfma_f32_16x16x32_bf16 a[12:15], v[68:71], v[76:79], a[12:15]
  v_mfma_f32_16x16x32_bf16 a[16:19], v[68:71], v[80:83], a[16:19]
  v_mfma_f32_16x16x32_bf16 a[20:23], v[68:71], v[84:87], a[20:23]
  v_mfma_f32_16x16x32_bf16 a[24:27], v[72:75], v[76:79], a[24:27]
  v_mfma_f32_16x16x32_bf16 a[28:31], v[72:75], v[80:83], a[28:31]
  v_mfma_f32_16x16x32_bf16 a[32:35], v[72:75], v[84:87], a[32:35]
  v_accvgpr_read_b32 v5, a36
  buffer_load_dwordx4 v[232:235], v5, s[36:39], 0 offen
  s_cmp_eq_u32 s26, 0
  s_cbranch_scc0 K3_XS0
  buffer_load_short_d16 v235, v5, s[36:39], 0 offen offset:12
K3_XS0:
  v_accvgpr_read_b32 v6, a41
  buffer_load_dwordx4 v[236:239], v6, s[36:39], 0 offen
  s_cmp_eq_u32 s26, 0
  s_cbranch_scc0 K3_XS1
  buffer_load_short_d16 v239, v6, s[36:39], 0 offen offset:12
K3_XS1:
  v_accvgpr_read_b32 v5, a46
  buffer_load_dwordx4 v[240:243], v5, s[36:39], 0 offen
  s_cmp_eq_u32 s26, 0
  s_cbranch_scc0 K3_XS2
  buffer_load_short_d16 v243, v5, s[36:39], 0 offen offset:12
K3_XS2:
  v_accvgpr_read_b32 v6, a51
  buffer_load_dwordx4 v[244:247], v6, s[36:39], 0 offen
  s_cmp_eq_u32 s26, 0
  s_cbranch_scc0 K3_XS3
  buffer_load_short_d16 v247, v6, s[36:39], 0 offen offset:12
K3_XS3:
  v_accvgpr_read_b32 v5, a56
  buffer_load_dwordx4 v[248:251], v5, s[36:39], 0 offen
  s_cmp_eq_u32 s26, 0
  s_cbranch_scc0 K3_XS4
  buffer_load_short_d16 v251, v5, s[36:39], 0 offen offset:12
K3_XS4:
  s_waitcnt vmcnt(35)
  v_mfma_f32_16x16x32_bf16 a[0:3], v[88:91], v[100:103], a[0:3]
  v_mfma_f32_16x16x32_bf16 a[4:7], v[88:91], v[104:107], a[4:7]
  v_mfma_f32_16x16x32_bf16 a[8:11], v[88:91], v[108:111], a[8:11]
  v_mfma_f32_16x16x32_bf16 a[12:15], v[92:95], v[100:103], a[12:15]
  v_mfma_f32_16x16x32_bf16 a[16:19], v[92:95], v[104:107], a[16:19]
  v_mfma_f32_16x16x32_bf16 a[20:23], v[92:95], v[108:111], a[20:23]
  v_mfma_f32_16x16x32_bf16 a[24:27], v[96:99], v[100:103], a[24:27]
  v_mfma_f32_16x16x32_bf16 a[28:31], v[96:99], v[104:107], a[28:31]
  v_mfma_f32_16x16x32_bf16 a[32:35], v[96:99], v[108:111], a[32:35]
  s_waitcnt vmcnt(29)
  v_mfma_f32_16x16x32_bf16 a[0:3], v[112:115], v[124:127], a[0:3]
  v_mfma_f32_16x16x32_bf16 a[4:7], v[112:115], v[128:131], a[4:7]
  v_mfma_f32_16x16x32_bf16 a[8:11], v[112:115], v[132:135], a[8:11]
  v_mfma_f32_16x16x32_bf16 a[12:15], v[116:119], v[124:127], a[12:15]
  v_mfma_f32_16x16x32_bf16 a[16:19], v[116:119], v[128:131], a[16:19]
  v_mfma_f32_16x16x32_bf16 a[20:23], v[116:119], v[132:135], a[20:23]
  v_mfma_f32_16x16x32_bf16 a[24:27], v[120:123], v[124:127], a[24:27]
  v_mfma_f32_16x16x32_bf16 a[28:31], v[120:123], v[128:131], a[28:31]
  v_mfma_f32_16x16x32_bf16 a[32:35], v[120:123], v[132:135], a[32:35]
  s_waitcnt vmcnt(23)
  v_mfma_f32_16x16x32_bf16 a[0:3], v[136:139], v[148:151], a[0:3]
  v_mfma_f32_16x16x32_bf16 a[4:7], v[136:139], v[152:155], a[4:7]
  v_mfma_f32_16x16x32_bf16 a[8:11], v[136:139], v[156:159], a[8:11]
  v_mfma_f32_16x16x32_bf16 a[12:15], v[140:143], v[148:151], a[12:15]
  v_mfma_f32_16x16x32_bf16 a[16:19], v[140:143], v[152:155], a[16:19]
  v_mfma_f32_16x16x32_bf16 a[20:23], v[140:143], v[156:159], a[20:23]
  v_mfma_f32_16x16x32_bf16 a[24:27], v[144:147], v[148:151], a[24:27]
  v_mfma_f32_16x16x32_bf16 a[28:31], v[144:147], v[152:155], a[28:31]
  v_mfma_f32_16x16x32_bf16 a[32:35], v[144:147], v[156:159], a[32:35]
  s_waitcnt vmcnt(17)
  v_mfma_f32_16x16x32_bf16 a[0:3], v[160:163], v[172:175], a[0:3]
  v_mfma_f32_16x16x32_bf16 a[4:7], v[160:163], v[176:179], a[4:7]
  v_mfma_f32_16x16x32_bf16 a[8:11], v[160:163], v[180:183], a[8:11]
  v_mfma_f32_16x16x32_bf16 a[12:15], v[164:167], v[172:175], a[12:15]
  v_mfma_f32_16x16x32_bf16 a[16:19], v[164:167], v[176:179], a[16:19]
  v_mfma_f32_16x16x32_bf16 a[20:23], v[164:167], v[180:183], a[20:23]
  v_mfma_f32_16x16x32_bf16 a[24:27], v[168:171], v[172:175], a[24:27]
  v_mfma_f32_16x16x32_bf16 a[28:31], v[168:171], v[176:179], a[28:31]
  v_mfma_f32_16x16x32_bf16 a[32:35], v[168:171], v[180:183], a[32:35]
  s_waitcnt vmcnt(11)
  v_mfma_f32_16x16x32_bf16 a[0:3], v[184:187], v[196:199], a[0:3]
  v_mfma_f32_16x16x32_bf16 a[4:7], v[184:187], v[200:203], a[4:7]
  v_mfma_f32_16x16x32_bf16 a[8:11], v[184:187], v[204:207], a[8:11]
  v_mfma_f32_16x16x32_bf16 a[12:15], v[188:191], v[196:199], a[12:15]
  v_mfma_f32_16x16x32_bf16 a[16:19], v[188:191], v[200:203], a[16:19]
  v_mfma_f32_16x16x32_bf16 a[20:23], v[188:191], v[204:207], a[20:23]
  v_mfma_f32_16x16x32_bf16 a[24:27], v[192:195], v[196:199], a[24:27]
  v_mfma_f32_16x16x32_bf16 a[28:31], v[192:195], v[200:203], a[28:31]
  v_mfma_f32_16x16x32_bf16 a[32:35], v[192:195], v[204:207], a[32:35]
  s_waitcnt vmcnt(5)
  v_mfma_f32_16x16x32_bf16 a[0:3], v[208:211], v[220:223], a[0:3]
  v_mfma_f32_16x16x32_bf16 a[4:7], v[208:211], v[224:227], a[4:7]
  v_mfma_f32_16x16x32_bf16 a[8:11], v[208:211], v[228:231], a[8:11]
  v_mfma_f32_16x16x32_bf16 a[12:15], v[212:215], v[220:223], a[12:15]
  v_mfma_f32_16x16x32_bf16 a[16:19], v[212:215], v[224:227], a[16:19]
  v_mfma_f32_16x16x32_bf16 a[20:23], v[212:215], v[228:231], a[20:23]
  v_mfma_f32_16x16x32_bf16 a[24:27], v[216:219], v[220:223], a[24:27]
  v_mfma_f32_16x16x32_bf16 a[28:31], v[216:219], v[224:227], a[28:31]
  v_mfma_f32_16x16x32_bf16 a[32:35], v[216:219], v[228:231], a[32:35]
  s_nop 7
  s_nop 1
  s_mul_i32 s35, s3, 9216
  v_lshlrev_b32 v5, 4, v1
  v_add_u32 v6, s35, v5
  v_accvgpr_read_b32 v16, a0
  v_accvgpr_read_b32 v17, a1
  v_accvgpr_read_b32 v18, a2
  v_accvgpr_read_b32 v19, a3
  v_accvgpr_read_b32 v20, a4
  v_accvgpr_read_b32 v21, a5
  v_accvgpr_read_b32 v22, a6
  v_accvgpr_read_b32 v23, a7
  v_accvgpr_read_b32 v24, a8
  v_accvgpr_read_b32 v25, a9
  v_accvgpr_read_b32 v26, a10
  v_accvgpr_read_b32 v27, a11
  v_accvgpr_read_b32 v28, a12
  v_accvgpr_read_b32 v29, a13
  v_accvgpr_read_b32 v30, a14
  v_accvgpr_read_b32 v31, a15
  v_accvgpr_read_b32 v32, a16
  v_accvgpr_read_b32 v33, a17
  v_accvgpr_read_b32 v34, a18
  v_accvgpr_read_b32 v35, a19
  v_accvgpr_read_b32 v36, a20
  v_accvgpr_read_b32 v37, a21
  v_accvgpr_read_b32 v38, a22
  v_accvgpr_read_b32 v39, a23
  v_accvgpr_read_b32 v40, a24
  v_accvgpr_read_b32 v41, a25
  v_accvgpr_read_b32 v42, a26
  v_accvgpr_read_b32 v43, a27
  v_accvgpr_read_b32 v44, a28
  v_accvgpr_read_b32 v45, a29
  v_accvgpr_read_b32 v46, a30
  v_accvgpr_read_b32 v47, a31
  v_accvgpr_read_b32 v48, a32
  v_accvgpr_read_b32 v49, a33
  v_accvgpr_read_b32 v50, a34
  v_accvgpr_read_b32 v51, a35
  ds_write_b128 v6, v[16:19] offset:0
  ds_write_b128 v6, v[20:23] offset:1024
  ds_write_b128 v6, v[24:27] offset:2048
  ds_write_b128 v6, v[28:31] offset:3072
  ds_write_b128 v6, v[32:35] offset:4096
  ds_write_b128 v6, v[36:39] offset:5120
  ds_write_b128 v6, v[40:43] offset:6144
  ds_write_b128 v6, v[44:47] offset:7168
  ds_write_b128 v6, v[48:51] offset:8192
  s_waitcnt vmcnt(0) lgkmcnt(0)
  s_barrier
  v_mul_u32_u24 v60, 208, v3
  v_add_u32 v60, 46080, v60
  v_lshlrev_b32 v61, 4, v4
  v_sub_u32 v62, v60, v61
  v_add_u32 v61, v60, v61
  s_lshl_b32 s56, s47, 10
  v_add_u32 v6, s56, v5
  ds_read_b128 v[16:19], v6 offset:0
  ds_read_b128 v[20:23], v6 offset:9216
  ds_read_b128 v[24:27], v6 offset:18432
  ds_read_b128 v[28:31], v6 offset:27648
  v_add_u32 v7, s46, v61
  v_add_u32 v8, s64, v62
  s_waitcnt lgkmcnt(0)
  v_add_f32 v16, v16, v24
  v_add_f32 v20, v20, v28
  v_sub_f32 v32, v16, v20
  v_add_f32 v36, v16, v20
  v_sub_f32 v43, v16, v20
  v_add_f32 v47, v16, v20
  v_add_f32 v17, v17, v25
  v_add_f32 v21, v21, v29
  v_sub_f32 v33, v17, v21
  v_add_f32 v37, v17, v21
  v_sub_f32 v42, v17, v21
  v_add_f32 v46, v17, v21
  v_add_f32 v18, v18, v26
  v_add_f32 v22, v22, v30
  v_sub_f32 v34, v18, v22
  v_add_f32 v38, v18, v22
  v_sub_f32 v41, v18, v22
  v_add_f32 v45, v18, v22
  v_add_f32 v19, v19, v27
  v_add_f32 v23, v23, v31
  v_sub_f32 v35, v19, v23
  v_add_f32 v39, v19, v23
  v_sub_f32 v40, v19, v23
  v_add_f32 v44, v19, v23
  ds_write_b128 v7, v[32:35]
  ds_write_b128 v8, v[44:47] offset:9984
  ds_write_b128 v7, v[36:39] offset:19968
  ds_write_b128 v8, v[40:43] offset:29952
  s_lshl_b32 s56, s51, 10
  v_add_u32 v6, s56, v5
  ds_read_b128 v[16:19], v6 offset:0
  ds_read_b128 v[20:23], v6 offset:9216
  ds_read_b128 v[24:27], v6 offset:18432
  ds_read_b128 v[28:31], v6 offset:27648
  v_add_u32 v7, s50, v61
  v_add_u32 v8, s65, v62
  s_waitcnt lgkmcnt(0)
  v_add_f32 v16, v16, v24
  v_add_f32 v20, v20, v28
  v_sub_f32 v32, v16, v20
  v_add_f32 v36, v16, v20
  v_sub_f32 v43, v16, v20
  v_add_f32 v47, v16, v20
  v_add_f32 v17, v17, v25
  v_add_f32 v21, v21, v29
  v_sub_f32 v33, v17, v21
  v_add_f32 v37, v17, v21
  v_sub_f32 v42, v17, v21
  v_add_f32 v46, v17, v21
  v_add_f32 v18, v18, v26
  v_add_f32 v22, v22, v30
  v_sub_f32 v34, v18, v22
  v_add_f32 v38, v18, v22
  v_sub_f32 v41, v18, v22
  v_add_f32 v45, v18, v22
  v_add_f32 v19, v19, v27
  v_add_f32 v23, v23, v31
  v_sub_f32 v35, v19, v23
  v_add_f32 v39, v19, v23
  v_sub_f32 v40, v19, v23
  v_add_f32 v44, v19, v23
  ds_write_b128 v7, v[32:35]
  ds_write_b128 v8, v[44:47] offset:9984
  ds_write_b128 v7, v[36:39] offset:19968
  ds_write_b128 v8, v[40:43] offset:29952
  s_cmp_gt_u32 s3, 0
  s_cbranch_scc1 K3_PHC
  s_lshl_b32 s56, s55, 10
  v_add_u32 v6, s56, v5
  ds_read_b128 v[16:19], v6 offset:0
  ds_read_b128 v[20:23], v6 offset:9216
  ds_read_b128 v[24:27], v6 offset:18432
  ds_read_b128 v[28:31], v6 offset:27648
  v_add_u32 v7, s54, v61
  v_add_u32 v8, s66, v62
  s_waitcnt lgkmcnt(0)
  v_add_f32 v16, v16, v24
  v_add_f32 v20, v20, v28
  v_sub_f32 v32, v16, v20
  v_add_f32 v36, v16, v20
  v_sub_f32 v43, v16, v20
  v_add_f32 v47, v16, v20
  v_add_f32 v17, v17, v25
  v_add_f32 v21, v21, v29
  v_sub_f32 v33, v17, v21
  v_add_f32 v37, v17, v21
  v_sub_f32 v42, v17, v21
  v_add_f32 v46, v17, v21
  v_add_f32 v18, v18, v26
  v_add_f32 v22, v22, v30
  v_sub_f32 v34, v18, v22
  v_add_f32 v38, v18, v22
  v_sub_f32 v41, v18, v22
  v_add_f32 v45, v18, v22
  v_add_f32 v19, v19, v27
  v_add_f32 v23, v23, v31
  v_sub_f32 v35, v19, v23
  v_add_f32 v39, v19, v23
  v_sub_f32 v40, v19, v23
  v_add_f32 v44, v19, v23
  ds_write_b128 v7, v[32:35]
  ds_write_b128 v8, v[44:47] offset:9984
  ds_write_b128 v7, v[36:39] offset:19968
  ds_write_b128 v8, v[40:43] offset:29952
K3_PHC:
  s_waitcnt lgkmcnt(0)
  s_barrier
  s_cmp_eq_u32 s26, 0
  s_cselect_b32 s66, 1, 0
  s_cmp_eq_u32 s26, 10
  s_cselect_b32 s66, 1, s66
  v_accvgpr_read_b32 v104, a36
  v_accvgpr_read_b32 v105, a37
  v_accvgpr_read_b32 v106, a38
  v_accvgpr_read_b32 v107, a39
  v_accvgpr_read_b32 v108, a40
  v_accvgpr_read_b32 v109, a41
  v_accvgpr_read_b32 v110, a42
  v_accvgpr_read_b32 v111, a43
  v_accvgpr_read_b32 v112, a44
  v_accvgpr_read_b32 v113, a45
  v_accvgpr_read_b32 v114, a46
  v_accvgpr_read_b32 v115, a47
  v_accvgpr_read_b32 v116, a48
  v_accvgpr_read_b32 v117, a49
  v_accvgpr_read_b32 v118, a50
  v_accvgpr_read_b32 v119, a51
  v_accvgpr_read_b32 v120, a52
  v_accvgpr_read_b32 v121, a53
  v_accvgpr_read_b32 v122, a54
  v_accvgpr_read_b32 v123, a55
  v_accvgpr_read_b32 v124, a56
  v_accvgpr_read_b32 v125, a57
  v_accvgpr_read_b32 v126, a58
  v_accvgpr_read_b32 v127, a59
  v_accvgpr_read_b32 v128, a60
  ds_read_b128 v[64:67], v105
  ds_read_b128 v[68:71], v105 offset:16
  ds_read_b128 v[72:75], v110
  ds_read_b128 v[76:79], v110 offset:16
  ds_read_b128 v[80:83], v115
  ds_read_b128 v[84:87], v115 offset:16
  ds_read_b128 v[88:91], v120
  ds_read_b128 v[92:95], v120 offset:16
  ds_read_b128 v[96:99], v125
  ds_read_b128 v[100:103], v125 offset:16
  v_lshlrev_b32 v28, 16, v232
  v_and_b32 v29, 0xffff0000, v232
  v_lshlrev_b32 v30, 16, v233
  v_and_b32 v31, 0xffff0000, v233
  v_lshlrev_b32 v32, 16, v234
  v_and_b32 v33, 0xffff0000, v234
  v_lshlrev_b32 v34, 16, v235
  v_and_b32 v35, 0xffff0000, v235
  s_waitcnt lgkmcnt(8)
  v_pk_add_f32 v[28:29], v[28:29], v[64:65]
  v_pk_add_f32 v[30:31], v[30:31], v[66:67]
  v_pk_add_f32 v[32:33], v[32:33], v[68:69]
  v_pk_add_f32 v[34:35], v[34:35], v[70:71]
  v_cvt_pk_bf16_f32 v36, v28, v29
  v_cvt_pk_bf16_f32 v37, v30, v31
  v_cvt_pk_bf16_f32 v38, v32, v33
  v_cvt_pk_bf16_f32 v39, v34, v35
  v_cmp_eq_u32 vcc, 8, v108
  v_lshlrev_b32 v28, 16, v36
  v_and_b32 v29, 0xffff0000, v36
  v_lshlrev_b32 v30, 16, v37
  v_and_b32 v31, 0xffff0000, v37
  v_lshlrev_b32 v32, 16, v38
  v_and_b32 v33, 0xffff0000, v38
  v_lshlrev_b32 v34, 16, v39
  v_and_b32 v35, 0xffff0000, v39
  s_and_saveexec_b64 s[70:71], vcc
  buffer_store_dwordx4 v[36:39], v104, s[20:23], 0 offen
  s_mov_b64 exec, s[70:71]
  s_cmp_eq_u32 s66, 0
  s_cbranch_scc1 K3_NE0
  s_mov_b64 s[56:57], vcc
  v_sub_u32 v40, 0, v107
  v_cmp_lt_u32 vcc, v40, v108
  s_nop 1
  v_cndmask_b32 v28, 0, v28, vcc
  s_andn2_b64 vcc, vcc, s[56:57]
  s_and_saveexec_b64 s[70:71], vcc
  buffer_store_short v36, v104, s[20:23], 0 offen offset:0
  s_mov_b64 exec, s[70:71]
  v_sub_u32 v40, 1, v107
  v_cmp_lt_u32 vcc, v40, v108
  s_nop 1
  v_cndmask_b32 v29, 0, v29, vcc
  s_andn2_b64 vcc, vcc, s[56:57]
  s_and_saveexec_b64 s[70:71], vcc
  buffer_store_short_d16_hi v36, v104, s[20:23], 0 offen offset:2
  s_mov_b64 exec, s[70:71]
  v_sub_u32 v40, 2, v107
  v_cmp_lt_u32 vcc, v40, v108
  s_nop 1
  v_cndmask_b32 v30, 0, v30, vcc
  s_andn2_b64 vcc, vcc, s[56:57]
  s_and_saveexec_b64 s[70:71], vcc
  buffer_store_short v37, v104, s[20:23], 0 offen offset:4
  s_mov_b64 exec, s[70:71]
  v_sub_u32 v40, 3, v107
  v_cmp_lt_u32 vcc, v40, v108
  s_nop 1
  v_cndmask_b32 v31, 0, v31, vcc
  s_andn2_b64 vcc, vcc, s[56:57]
  s_and_saveexec_b64 s[70:71], vcc
  buffer_store_short_d16_hi v37, v104, s[20:23], 0 offen offset:6
  s_mov_b64 exec, s[70:71]
  v_sub_u32 v40, 4, v107
  v_cmp_lt_u32 vcc, v40, v108
  s_nop 1
  v_cndmask_b32 v32, 0, v32, vcc
  s_andn2_b64 vcc, vcc, s[56:57]
  s_and_saveexec_b64 s[70:71], vcc
  buffer_store_short v38, v104, s[20:23], 0 offen offset:8
  s_mov_b64 exec, s[70:71]
  v_sub_u32 v40, 5, v107
  v_cmp_lt_u32 vcc, v40, v108
  s_nop 1
  v_cndmask_b32 v33, 0, v33, vcc
  s_andn2_b64 vcc, vcc, s[56:57]
  s_and_saveexec_b64 s[70:71], vcc
  buffer_store_short_d16_hi v38, v104, s[20:23], 0 offen offset:10
  s_mov_b64 exec, s[70:71]
  v_sub_u32 v40, 6, v107
  v_cmp_lt_u32 vcc, v40, v108
  s_nop 1
  v_cndmask_b32 v34, 0, v34, vcc
  s_andn2_b64 vcc, vcc, s[56:57]
  s_and_saveexec_b64 s[70:71], vcc
  buffer_store_short v39, v104, s[20:23], 0 offen offset:12
  s_mov_b64 exec, s[70:71]
  v_sub_u32 v40, 7, v107
  v_cmp_lt_u32 vcc, v40, v108
  s_nop 1
  v_cndmask_b32 v35, 0, v35, vcc
  s_andn2_b64 vcc, vcc, s[56:57]
  s_and_saveexec_b64 s[70:71], vcc
  buffer_store_short_d16_hi v39, v104, s[20:23], 0 offen offset:14
  s_mov_b64 exec, s[70:71]
K3_NE0:
  v_cmp_lt_u32 vcc, 0, v108
  v_pk_add_f32 v[40:41], v[28:29], v[30:31]
  v_pk_mul_f32 v[42:43], v[28:29], v[28:29]
  v_pk_add_f32 v[44:45], v[32:33], v[34:35]
  v_pk_fma_f32 v[42:43], v[30:31], v[30:31], v[42:43]
  v_pk_add_f32 v[40:41], v[40:41], v[44:45]
  v_pk_fma_f32 v[42:43], v[32:33], v[32:33], v[42:43]
  v_add_f32 v40, v40, v41
  v_pk_fma_f32 v[42:43], v[34:35], v[34:35], v[42:43]
  v_cndmask_b32 v46, 0, v40, vcc
  v_add_f32 v41, v42, v43
  v_cndmask_b32 v47, 0, v41, vcc
  ds_write_b64 v106, v[46:47]
  v_lshlrev_b32 v28, 16, v236
  v_and_b32 v29, 0xffff0000, v236
  v_lshlrev_b32 v30, 16, v237
  v_and_b32 v31, 0xffff0000, v237
  v_lshlrev_b32 v32, 16, v238
  v_and_b32 v33, 0xffff0000, v238
  v_lshlrev_b32 v34, 16, v239
  v_and_b32 v35, 0xffff0000, v239
  s_waitcnt lgkmcnt(7)
  v_pk_add_f32 v[28:29], v[28:29], v[72:73]
  v_pk_add_f32 v[30:31], v[30:31], v[74:75]
  v_pk_add_f32 v[32:33], v[32:33], v[76:77]
  v_pk_add_f32 v[34:35], v[34:35], v[78:79]
  v_cvt_pk_bf16_f32 v36, v28, v29
  v_cvt_pk_bf16_f32 v37, v30, v31
  v_cvt_pk_bf16_f32 v38, v32, v33
  v_cvt_pk_bf16_f32 v39, v34, v35
  v_cmp_eq_u32 vcc, 8, v113
  v_lshlrev_b32 v28, 16, v36
  v_and_b32 v29, 0xffff0000, v36
  v_lshlrev_b32 v30, 16, v37
  v_and_b32 v31, 0xffff0000, v37
  v_lshlrev_b32 v32, 16, v38
  v_and_b32 v33, 0xffff0000, v38
  v_lshlrev_b32 v34, 16, v39
  v_and_b32 v35, 0xffff0000, v39
  s_and_saveexec_b64 s[70:71], vcc
  buffer_store_dwordx4 v[36:39], v109, s[20:23], 0 offen
  s_mov_b64 exec, s[70:71]
  s_cmp_eq_u32 s66, 0
  s_cbranch_scc1 K3_NE1
  s_mov_b64 s[56:57], vcc
  v_sub_u32 v40, 0, v112
  v_cmp_lt_u32 vcc, v40, v113
  s_nop 1
  v_cndmask_b32 v28, 0, v28, vcc
  s_andn2_b64 vcc, vcc, s[56:57]
  s_and_saveexec_b64 s[70:71], vcc
  buffer_store_short v36, v109, s[20:23], 0 offen offset:0
  s_mov_b64 exec, s[70:71]
  v_sub_u32 v40, 1, v112
  v_cmp_lt_u32 vcc, v40, v113
  s_nop 1
  v_cndmask_b32 v29, 0, v29, vcc
  s_andn2_b64 vcc, vcc, s[56:57]
  s_and_saveexec_b64 s[70:71], vcc
  buffer_store_short_d16_hi v36, v109, s[20:23], 0 offen offset:2
  s_mov_b64 exec, s[70:71]
  v_sub_u32 v40, 2, v112
  v_cmp_lt_u32 vcc, v40, v113
  s_nop 1
  v_cndmask_b32 v30, 0, v30, vcc
  s_andn2_b64 vcc, vcc, s[56:57]
  s_and_saveexec_b64 s[70:71], vcc
  buffer_store_short v37, v109, s[20:23], 0 offen offset:4
  s_mov_b64 exec, s[70:71]
  v_sub_u32 v40, 3, v112
  v_cmp_lt_u32 vcc, v40, v113
  s_nop 1
  v_cndmask_b32 v31, 0, v31, vcc
  s_andn2_b64 vcc, vcc, s[56:57]
  s_and_saveexec_b64 s[70:71], vcc
  buffer_store_short_d16_hi v37, v109, s[20:23], 0 offen offset:6
  s_mov_b64 exec, s[70:71]
  v_sub_u32 v40, 4, v112
  v_cmp_lt_u32 vcc, v40, v113
  s_nop 1
  v_cndmask_b32 v32, 0, v32, vcc
  s_andn2_b64 vcc, vcc, s[56:57]
  s_and_saveexec_b64 s[70:71], vcc
  buffer_store_short v38, v109, s[20:23], 0 offen offset:8
  s_mov_b64 exec, s[70:71]
  v_sub_u32 v40, 5, v112
  v_cmp_lt_u32 vcc, v40, v113
  s_nop 1
  v_cndmask_b32 v33, 0, v33, vcc
  s_andn2_b64 vcc, vcc, s[56:57]
  s_and_saveexec_b64 s[70:71], vcc
  buffer_store_short_d16_hi v38, v109, s[20:23], 0 offen offset:10
  s_mov_b64 exec, s[70:71]
  v_sub_u32 v40, 6, v112
  v_cmp_lt_u32 vcc, v40, v113
  s_nop 1
  v_cndmask_b32 v34, 0, v34, vcc
  s_andn2_b64 vcc, vcc, s[56:57]
  s_and_saveexec_b64 s[70:71], vcc
  buffer_store_short v39, v109, s[20:23], 0 offen offset:12
  s_mov_b64 exec, s[70:71]
  v_sub_u32 v40, 7, v112
  v_cmp_lt_u32 vcc, v40, v113
  s_nop 1
  v_cndmask_b32 v35, 0, v35, vcc
  s_andn2_b64 vcc, vcc, s[56:57]
  s_and_saveexec_b64 s[70:71], vcc
  buffer_store_short_d16_hi v39, v109, s[20:23], 0 offen offset:14
  s_mov_b64 exec, s[70:71]
K3_NE1:
  v_cmp_lt_u32 vcc, 0, v113
  v_pk_add_f32 v[40:41], v[28:29], v[30:31]
  v_pk_mul_f32 v[42:43], v[28:29], v[28:29]
  v_pk_add_f32 v[44:45], v[32:33], v[34:35]
  v_pk_fma_f32 v[42:43], v[30:31], v[30:31], v[42:43]
  v_pk_add_f32 v[40:41], v[40:41], v[44:45]
  v_pk_fma_f32 v[42:43], v[32:33], v[32:33], v[42:43]
  v_add_f32 v40, v40, v41
  v_pk_fma_f32 v[42:43], v[34:35], v[34:35], v[42:43]
  v_cndmask_b32 v46, 0, v40, vcc
  v_add_f32 v41, v42, v43
  v_cndmask_b32 v47, 0, v41, vcc
  ds_write_b64 v111, v[46:47]
  v_lshlrev_b32 v28, 16, v240
  v_and_b32 v29, 0xffff0000, v240
  v_lshlrev_b32 v30, 16, v241
  v_and_b32 v31, 0xffff0000, v241
  v_lshlrev_b32 v32, 16, v242
  v_and_b32 v33, 0xffff0000, v242
  v_lshlrev_b32 v34, 16, v243
  v_and_b32 v35, 0xffff0000, v243
  s_waitcnt lgkmcnt(6)
  v_pk_add_f32 v[28:29], v[28:29], v[80:81]
  v_pk_add_f32 v[30:31], v[30:31], v[82:83]
  v_pk_add_f32 v[32:33], v[32:33], v[84:85]
  v_pk_add_f32 v[34:35], v[34:35], v[86:87]
  v_cvt_pk_bf16_f32 v36, v28, v29
  v_cvt_pk_bf16_f32 v37, v30, v31
  v_cvt_pk_bf16_f32 v38, v32, v33
  v_cvt_pk_bf16_f32 v39, v34, v35
  v_cmp_eq_u32 vcc, 8, v118
  v_lshlrev_b32 v28, 16, v36
  v_and_b32 v29, 0xffff0000, v36
  v_lshlrev_b32 v30, 16, v37
  v_and_b32 v31, 0xffff0000, v37
  v_lshlrev_b32 v32, 16, v38
  v_and_b32 v33, 0xffff0000, v38
  v_lshlrev_b32 v34, 16, v39
  v_and_b32 v35, 0xffff0000, v39
  s_and_saveexec_b64 s[70:71], vcc
  buffer_store_dwordx4 v[36:39], v114, s[20:23], 0 offen
  s_mov_b64 exec, s[70:71]
  s_cmp_eq_u32 s66, 0
  s_cbranch_scc1 K3_NE2
  s_mov_b64 s[56:57], vcc
  v_sub_u32 v40, 0, v117
  v_cmp_lt_u32 vcc, v40, v118
  s_nop 1
  v_cndmask_b32 v28, 0, v28, vcc
  s_andn2_b64 vcc, vcc, s[56:57]
  s_and_saveexec_b64 s[70:71], vcc
  buffer_store_short v36, v114, s[20:23], 0 offen offset:0
  s_mov_b64 exec, s[70:71]
  v_sub_u32 v40, 1, v117
  v_cmp_lt_u32 vcc, v40, v118
  s_nop 1
  v_cndmask_b32 v29, 0, v29, vcc
  s_andn2_b64 vcc, vcc, s[56:57]
  s_and_saveexec_b64 s[70:71], vcc
  buffer_store_short_d16_hi v36, v114, s[20:23], 0 offen offset:2
  s_mov_b64 exec, s[70:71]
  v_sub_u32 v40, 2, v117
  v_cmp_lt_u32 vcc, v40, v118
  s_nop 1
  v_cndmask_b32 v30, 0, v30, vcc
  s_andn2_b64 vcc, vcc, s[56:57]
  s_and_saveexec_b64 s[70:71], vcc
  buffer_store_short v37, v114, s[20:23], 0 offen offset:4
  s_mov_b64 exec, s[70:71]
  v_sub_u32 v40, 3, v117
  v_cmp_lt_u32 vcc, v40, v118
  s_nop 1
  v_cndmask_b32 v31, 0, v31, vcc
  s_andn2_b64 vcc, vcc, s[56:57]
  s_and_saveexec_b64 s[70:71], vcc
  buffer_store_short_d16_hi v37, v114, s[20:23], 0 offen offset:6
  s_mov_b64 exec, s[70:71]
  v_sub_u32 v40, 4, v117
  v_cmp_lt_u32 vcc, v40, v118
  s_nop 1
  v_cndmask_b32 v32, 0, v32, vcc
  s_andn2_b64 vcc, vcc, s[56:57]
  s_and_saveexec_b64 s[70:71], vcc
  buffer_store_short v38, v114, s[20:23], 0 offen offset:8
  s_mov_b64 exec, s[70:71]
  v_sub_u32 v40, 5, v117
  v_cmp_lt_u32 vcc, v40, v118
  s_nop 1
  v_cndmask_b32 v33, 0, v33, vcc
  s_andn2_b64 vcc, vcc, s[56:57]
  s_and_saveexec_b64 s[70:71], vcc
  buffer_store_short_d16_hi v38, v114, s[20:23], 0 offen offset:10
  s_mov_b64 exec, s[70:71]
  v_sub_u32 v40, 6, v117
  v_cmp_lt_u32 vcc, v40, v118
  s_nop 1
  v_cndmask_b32 v34, 0, v34, vcc
  s_andn2_b64 vcc, vcc, s[56:57]
  s_and_saveexec_b64 s[70:71], vcc
  buffer_store_short v39, v114, s[20:23], 0 offen offset:12
  s_mov_b64 exec, s[70:71]
  v_sub_u32 v40, 7, v117
  v_cmp_lt_u32 vcc, v40, v118
  s_nop 1
  v_cndmask_b32 v35, 0, v35, vcc
  s_andn2_b64 vcc, vcc, s[56:57]
  s_and_saveexec_b64 s[70:71], vcc
  buffer_store_short_d16_hi v39, v114, s[20:23], 0 offen offset:14
  s_mov_b64 exec, s[70:71]
K3_NE2:
  v_cmp_lt_u32 vcc, 0, v118
  v_pk_add_f32 v[40:41], v[28:29], v[30:31]
  v_pk_mul_f32 v[42:43], v[28:29], v[28:29]
  v_pk_add_f32 v[44:45], v[32:33], v[34:35]
  v_pk_fma_f32 v[42:43], v[30:31], v[30:31], v[42:43]
  v_pk_add_f32 v[40:41], v[40:41], v[44:45]
  v_pk_fma_f32 v[42:43], v[32:33], v[32:33], v[42:43]
  v_add_f32 v40, v40, v41
  v_pk_fma_f32 v[42:43], v[34:35], v[34:35], v[42:43]
  v_cndmask_b32 v46, 0, v40, vcc
  v_add_f32 v41, v42, v43
  v_cndmask_b32 v47, 0, v41, vcc
  ds_write_b64 v116, v[46:47]
  v_lshlrev_b32 v28, 16, v244
  v_and_b32 v29, 0xffff0000, v244
  v_lshlrev_b32 v30, 16, v245
  v_and_b32 v31, 0xffff0000, v245
  v_lshlrev_b32 v32, 16, v246
  v_and_b32 v33, 0xffff0000, v246
  v_lshlrev_b32 v34, 16, v247
  v_and_b32 v35, 0xffff0000, v247
  s_waitcnt lgkmcnt(5)
  v_pk_add_f32 v[28:29], v[28:29], v[88:89]
  v_pk_add_f32 v[30:31], v[30:31], v[90:91]
  v_pk_add_f32 v[32:33], v[32:33], v[92:93]
  v_pk_add_f32 v[34:35], v[34:35], v[94:95]
  v_cvt_pk_bf16_f32 v36, v28, v29
  v_cvt_pk_bf16_f32 v37, v30, v31
  v_cvt_pk_bf16_f32 v38, v32, v33
  v_cvt_pk_bf16_f32 v39, v34, v35
  v_cmp_eq_u32 vcc, 8, v123
  v_lshlrev_b32 v28, 16, v36
  v_and_b32 v29, 0xffff0000, v36
  v_lshlrev_b32 v30, 16, v37
  v_and_b32 v31, 0xffff0000, v37
  v_lshlrev_b32 v32, 16, v38
  v_and_b32 v33, 0xffff0000, v38
  v_lshlrev_b32 v34, 16, v39
  v_and_b32 v35, 0xffff0000, v39
  s_and_saveexec_b64 s[70:71], vcc
  buffer_store_dwordx4 v[36:39], v119, s[20:23], 0 offen
  s_mov_b64 exec, s[70:71]
  s_cmp_eq_u32 s66, 0
  s_cbranch_scc1 K3_NE3
  s_mov_b64 s[56:57], vcc
  v_sub_u32 v40, 0, v122
  v_cmp_lt_u32 vcc, v40, v123
  s_nop 1
  v_cndmask_b32 v28, 0, v28, vcc
  s_andn2_b64 vcc, vcc, s[56:57]
  s_and_saveexec_b64 s[70:71], vcc
  buffer_store_short v36, v119, s[20:23], 0 offen offset:0
  s_mov_b64 exec, s[70:71]
  v_sub_u32 v40, 1, v122
  v_cmp_lt_u32 vcc, v40, v123
  s_nop 1
  v_cndmask_b32 v29, 0, v29, vcc
  s_andn2_b64 vcc, vcc, s[56:57]
  s_and_saveexec_b64 s[70:71], vcc
  buffer_store_short_d16_hi v36, v119, s[20:23], 0 offen offset:2
  s_mov_b64 exec, s[70:71]
  v_sub_u32 v40, 2, v122
  v_cmp_lt_u32 vcc, v40, v123
  s_nop 1
  v_cndmask_b32 v30, 0, v30, vcc
  s_andn2_b64 vcc, vcc, s[56:57]
  s_and_saveexec_b64 s[70:71], vcc
  buffer_store_short v37, v119, s[20:23], 0 offen offset:4
  s_mov_b64 exec, s[70:71]
  v_sub_u32 v40, 3, v122
  v_cmp_lt_u32 vcc, v40, v123
  s_nop 1
  v_cndmask_b32 v31, 0, v31, vcc
  s_andn2_b64 vcc, vcc, s[56:57]
  s_and_saveexec_b64 s[70:71], vcc
  buffer_store_short_d16_hi v37, v119, s[20:23], 0 offen offset:6
  s_mov_b64 exec, s[70:71]
  v_sub_u32 v40, 4, v122
  v_cmp_lt_u32 vcc, v40, v123
  s_nop 1
  v_cndmask_b32 v32, 0, v32, vcc
  s_andn2_b64 vcc, vcc, s[56:57]
  s_and_saveexec_b64 s[70:71], vcc
  buffer_store_short v38, v119, s[20:23], 0 offen offset:8
  s_mov_b64 exec, s[70:71]
  v_sub_u32 v40, 5, v122
  v_cmp_lt_u32 vcc, v40, v123
  s_nop 1
  v_cndmask_b32 v33, 0, v33, vcc
  s_andn2_b64 vcc, vcc, s[56:57]
  s_and_saveexec_b64 s[70:71], vcc
  buffer_store_short_d16_hi v38, v119, s[20:23], 0 offen offset:10
  s_mov_b64 exec, s[70:71]
  v_sub_u32 v40, 6, v122
  v_cmp_lt_u32 vcc, v40, v123
  s_nop 1
  v_cndmask_b32 v34, 0, v34, vcc
  s_andn2_b64 vcc, vcc, s[56:57]
  s_and_saveexec_b64 s[70:71], vcc
  buffer_store_short v39, v119, s[20:23], 0 offen offset:12
  s_mov_b64 exec, s[70:71]
  v_sub_u32 v40, 7, v122
  v_cmp_lt_u32 vcc, v40, v123
  s_nop 1
  v_cndmask_b32 v35, 0, v35, vcc
  s_andn2_b64 vcc, vcc, s[56:57]
  s_and_saveexec_b64 s[70:71], vcc
  buffer_store_short_d16_hi v39, v119, s[20:23], 0 offen offset:14
  s_mov_b64 exec, s[70:71]
K3_NE3:
  v_cmp_lt_u32 vcc, 0, v123
  v_pk_add_f32 v[40:41], v[28:29], v[30:31]
  v_pk_mul_f32 v[42:43], v[28:29], v[28:29]
  v_pk_add_f32 v[44:45], v[32:33], v[34:35]
  v_pk_fma_f32 v[42:43], v[30:31], v[30:31], v[42:43]
  v_pk_add_f32 v[40:41], v[40:41], v[44:45]
  v_pk_fma_f32 v[42:43], v[32:33], v[32:33], v[42:43]
  v_add_f32 v40, v40, v41
  v_pk_fma_f32 v[42:43], v[34:35], v[34:35], v[42:43]
  v_cndmask_b32 v46, 0, v40, vcc
  v_add_f32 v41, v42, v43
  v_cndmask_b32 v47, 0, v41, vcc
  ds_write_b64 v121, v[46:47]
  v_cmp_gt_u32 vcc, 128, v0
  s_and_saveexec_b64 s[78:79], vcc
  s_cbranch_execz K3_PD
  v_lshlrev_b32 v28, 16, v248
  v_and_b32 v29, 0xffff0000, v248
  v_lshlrev_b32 v30, 16, v249
  v_and_b32 v31, 0xffff0000, v249
  v_lshlrev_b32 v32, 16, v250
  v_and_b32 v33, 0xffff0000, v250
  v_lshlrev_b32 v34, 16, v251
  v_and_b32 v35, 0xffff0000, v251
  s_waitcnt lgkmcnt(4)
  v_pk_add_f32 v[28:29], v[28:29], v[96:97]
  v_pk_add_f32 v[30:31], v[30:31], v[98:99]
  v_pk_add_f32 v[32:33], v[32:33], v[100:101]
  v_pk_add_f32 v[34:35], v[34:35], v[102:103]
  v_cvt_pk_bf16_f32 v36, v28, v29
  v_cvt_pk_bf16_f32 v37, v30, v31
  v_cvt_pk_bf16_f32 v38, v32, v33
  v_cvt_pk_bf16_f32 v39, v34, v35
  v_cmp_eq_u32 vcc, 8, v128
  v_lshlrev_b32 v28, 16, v36
  v_and_b32 v29, 0xffff0000, v36
  v_lshlrev_b32 v30, 16, v37
  v_and_b32 v31, 0xffff0000, v37
  v_lshlrev_b32 v32, 16, v38
  v_and_b32 v33, 0xffff0000, v38
  v_lshlrev_b32 v34, 16, v39
  v_and_b32 v35, 0xffff0000, v39
  s_and_saveexec_b64 s[70:71], vcc
  buffer_store_dwordx4 v[36:39], v124, s[20:23], 0 offen
  s_mov_b64 exec, s[70:71]
  s_cmp_eq_u32 s66, 0
  s_cbranch_scc1 K3_NE4
  s_mov_b64 s[56:57], vcc
  v_sub_u32 v40, 0, v127
  v_cmp_lt_u32 vcc, v40, v128
  s_nop 1
  v_cndmask_b32 v28, 0, v28, vcc
  s_andn2_b64 vcc, vcc, s[56:57]
  s_and_saveexec_b64 s[70:71], vcc
  buffer_store_short v36, v124, s[20:23], 0 offen offset:0
  s_mov_b64 exec, s[70:71]
  v_sub_u32 v40, 1, v127
  v_cmp_lt_u32 vcc, v40, v128
  s_nop 1
  v_cndmask_b32 v29, 0, v29, vcc
  s_andn2_b64 vcc, vcc, s[56:57]
  s_and_saveexec_b64 s[70:71], vcc
  buffer_store_short_d16_hi v36, v124, s[20:23], 0 offen offset:2
  s_mov_b64 exec, s[70:71]
  v_sub_u32 v40, 2, v127
  v_cmp_lt_u32 vcc, v40, v128
  s_nop 1
  v_cndmask_b32 v30, 0, v30, vcc
  s_andn2_b64 vcc, vcc, s[56:57]
  s_and_saveexec_b64 s[70:71], vcc
  buffer_store_short v37, v124, s[20:23], 0 offen offset:4
  s_mov_b64 exec, s[70:71]
  v_sub_u32 v40, 3, v127
  v_cmp_lt_u32 vcc, v40, v128
  s_nop 1
  v_cndmask_b32 v31, 0, v31, vcc
  s_andn2_b64 vcc, vcc, s[56:57]
  s_and_saveexec_b64 s[70:71], vcc
  buffer_store_short_d16_hi v37, v124, s[20:23], 0 offen offset:6
  s_mov_b64 exec, s[70:71]
  v_sub_u32 v40, 4, v127
  v_cmp_lt_u32 vcc, v40, v128
  s_nop 1
  v_cndmask_b32 v32, 0, v32, vcc
  s_andn2_b64 vcc, vcc, s[56:57]
  s_and_saveexec_b64 s[70:71], vcc
  buffer_store_short v38, v124, s[20:23], 0 offen offset:8
  s_mov_b64 exec, s[70:71]
  v_sub_u32 v40, 5, v127
  v_cmp_lt_u32 vcc, v40, v128
  s_nop 1
  v_cndmask_b32 v33, 0, v33, vcc
  s_andn2_b64 vcc, vcc, s[56:57]
  s_and_saveexec_b64 s[70:71], vcc
  buffer_store_short_d16_hi v38, v124, s[20:23], 0 offen offset:10
  s_mov_b64 exec, s[70:71]
  v_sub_u32 v40, 6, v127
  v_cmp_lt_u32 vcc, v40, v128
  s_nop 1
  v_cndmask_b32 v34, 0, v34, vcc
  s_andn2_b64 vcc, vcc, s[56:57]
  s_and_saveexec_b64 s[70:71], vcc
  buffer_store_short v39, v124, s[20:23], 0 offen offset:12
  s_mov_b64 exec, s[70:71]
  v_sub_u32 v40, 7, v127
  v_cmp_lt_u32 vcc, v40, v128
  s_nop 1
  v_cndmask_b32 v35, 0, v35, vcc
  s_andn2_b64 vcc, vcc, s[56:57]
  s_and_saveexec_b64 s[70:71], vcc
  buffer_store_short_d16_hi v39, v124, s[20:23], 0 offen offset:14
  s_mov_b64 exec, s[70:71]
K3_NE4:
  v_cmp_lt_u32 vcc, 0, v128
  v_pk_add_f32 v[40:41], v[28:29], v[30:31]
  v_pk_mul_f32 v[42:43], v[28:29], v[28:29]
  v_pk_add_f32 v[44:45], v[32:33], v[34:35]
  v_pk_fma_f32 v[42:43], v[30:31], v[30:31], v[42:43]
  v_pk_add_f32 v[40:41], v[40:41], v[44:45]
  v_pk_fma_f32 v[42:43], v[32:33], v[32:33], v[42:43]
  v_add_f32 v40, v40, v41
  v_pk_fma_f32 v[42:43], v[34:35], v[34:35], v[42:43]
  v_cndmask_b32 v46, 0, v40, vcc
  v_add_f32 v41, v42, v43
  v_cndmask_b32 v47, 0, v41, vcc
  ds_write_b64 v126, v[46:47]
K3_PD:
  s_mov_b64 exec, s[78:79]
K3_SYNC:
  s_waitcnt lgkmcnt(0)
  s_barrier
  v_cmp_gt_u32 vcc, 96, v0
  s_and_saveexec_b64 s[70:71], vcc
  s_cbranch_execz K3_END
  v_mul_u32_u24 v5, 96, v0
  v_add_u32 v5, 36864, v5
  ds_read_b128 v[16:19], v5 offset:0
  ds_read_b128 v[20:23], v5 offset:16
  ds_read_b128 v[24:27], v5 offset:32
  ds_read_b128 v[28:31], v5 offset:48
  ds_read_b128 v[32:35], v5 offset:64
  ds_read_b128 v[36:39], v5 offset:80
  v_cmp_le_u32 vcc, 48, v0
  v_subrev_u32 v6, 48, v0
  s_mul_i32 s56, s25, 96
  s_add_u32 s56, s56, s24
  v_cndmask_b32 v6, v0, v6, vcc
  v_lshl_add_u32 v6, v6, 1, s56
  v_sub_u32 v7, 2048, v6
  v_cndmask_b32 v8, v6, v7, vcc
  v_mul_u32_u24 v8, 88, v8
  s_lshl_b32 s57, s26, 3
  v_add_u32 v8, s57, v8
  v_cmp_ge_u32 s[58:59], s72, v6
  v_cmp_ge_u32 s[60:61], s73, v6
  v_cmp_lt_u32 s[62:63], 0, v6
  s_and_b64 s[60:61], s[60:61], s[62:63]
  s_and_b64 s[60:61], s[60:61], vcc
  s_andn2_b64 s[58:59], s[58:59], vcc
  s_or_b64 s[58:59], s[58:59], s[60:61]
  s_waitcnt lgkmcnt(0)
  v_add_f32 v16, v16, v18
  v_add_f32 v17, v17, v19
  v_add_f32 v16, v16, v20
  v_add_f32 v17, v17, v21
  v_add_f32 v16, v16, v22
  v_add_f32 v17, v17, v23
  v_add_f32 v16, v16, v24
  v_add_f32 v17, v17, v25
  v_add_f32 v16, v16, v26
  v_add_f32 v17, v17, v27
  v_add_f32 v16, v16, v28
  v_add_f32 v17, v17, v29
  v_add_f32 v16, v16, v30
  v_add_f32 v17, v17, v31
  v_add_f32 v16, v16, v32
  v_add_f32 v17, v17, v33
  v_add_f32 v16, v16, v34
  v_add_f32 v17, v17, v35
  v_add_f32 v16, v16, v36
  v_add_f32 v17, v17, v37
  v_add_f32 v16, v16, v38
  v_add_f32 v17, v17, v39
  s_and_b64 exec, exec, s[58:59]
  buffer_store_dwordx2 v[16:17], v8, s[40:43], 0 offen
K3_END:
  s_endpgm
.globl ffn1_kernel
.p2align 8
.type ffn1_kernel,@function
ffn1_kernel:
  s_cmp_ge_u32 s2, 256
  s_cbranch_scc1 G1_END
  s_load_dwordx2 s[4:5], s[0:1], 48
  s_load_dwordx2 s[8:9], s[0:1], 80
  s_load_dwordx2 s[10:11], s[0:1], 64
  v_and_b32 v1, 63, v0
  v_lshrrev_b32 v2, 6, v0
  s_and_b32 s24, s2, 7
  v_readfirstlane_b32 s3, v2
  s_lshr_b32 s25, s2, 3
  s_and_b32 s26, s24, 1
  s_lshl_b32 s26, s26, 3
  s_and_b32 s27, s25, 7
  s_add_u32 s26, s26, s27
  s_lshr_b32 s27, s24, 1
  s_lshl_b32 s27, s27, 2
  s_lshr_b32 s28, s25, 3
  s_add_u32 s27, s27, s28
  s_lshl_b32 s26, s26, 7
  s_mul_i32 s27, s27, 224
  s_waitcnt lgkmcnt(0)
  s_mov_b32 s12, s4
  s_mov_b32 s13, s5
  s_mov_b32 s14, 7340032
  s_mov_b32 s15, 0x20000
  s_add_u32 s16, s8, 5242880
  s_addc_u32 s17, s9, 0
  s_mov_b32 s18, 4194304
  s_mov_b32 s19, 0x20000
  s_add_u32 s20, s8, 10485760
  s_addc_u32 s21, s9, 0
  s_mov_b32 s22, 14680064
  s_mov_b32 s23, 0x20000
  s_add_u32 s36, s8, 9437184
  s_addc_u32 s37, s9, 0
  s_mov_b32 s38, 180224
  s_mov_b32 s39, 0x20000
  s_add_u32 s40, s8, 9699328
  s_addc_u32 s41, s9, 0
  s_mov_b32 s42, 229376
  s_mov_b32 s43, 0x20000
  s_cmp_ge_u32 s3, 4
  s_cbranch_scc1 G1_LOADER
  s_and_b32 s28, s3, 1
  s_lshr_b32 s29, s3, 1
  v_and_b32 v3, 15, v1
  v_lshrrev_b32 v4, 4, v1
  v_mov_b32 v128, 0
  v_mov_b32 v129, 0
  v_mov_b32 v130, 0
  v_mov_b32 v131, 0
  v_mov_b32 v132, 0
  v_mov_b32 v133, 0
  v_mov_b32 v134, 0
  v_mov_b32 v135, 0
  v_mov_b32 v136, 0
  v_mov_b32 v137, 0
  v_mov_b32 v138, 0
  v_mov_b32 v139, 0
  v_mov_b32 v140, 0
  v_mov_b32 v141, 0
  v_mov_b32 v142, 0
  v_mov_b32 v143, 0
  v_mov_b32 v144, 0
  v_mov_b32 v145, 0
  v_mov_b32 v146, 0
  v_mov_b32 v147, 0
  v_mov_b32 v148, 0
  v_mov_b32 v149, 0
  v_mov_b32 v150, 0
  v_mov_b32 v151, 0
  v_mov_b32 v152, 0
  v_mov_b32 v153, 0
  v_mov_b32 v154, 0
  v_mov_b32 v155, 0
  v_mov_b32 v156, 0
  v_mov_b32 v157, 0
  v_mov_b32 v158, 0
  v_mov_b32 v159, 0
  v_mov_b32 v160, 0
  v_mov_b32 v161, 0
  v_mov_b32 v162, 0
  v_mov_b32 v163, 0
  v_mov_b32 v164, 0
  v_mov_b32 v165, 0
  v_mov_b32 v166, 0
  v_mov_b32 v167, 0
  v_mov_b32 v168, 0
  v_mov_b32 v169, 0
  v_mov_b32 v170, 0
  v_mov_b32 v171, 0
  v_mov_b32 v172, 0
  v_mov_b32 v173, 0
  v_mov_b32 v174, 0
  v_mov_b32 v175, 0
  v_mov_b32 v176, 0
  v_mov_b32 v177, 0
  v_mov_b32 v178, 0
  v_mov_b32 v179, 0
  v_mov_b32 v180, 0
  v_mov_b32 v181, 0
  v_mov_b32 v182, 0
  v_mov_b32 v183, 0
  v_mov_b32 v184, 0
  v_mov_b32 v185, 0
  v_mov_b32 v186, 0
  v_mov_b32 v187, 0
  v_mov_b32 v188, 0
  v_mov_b32 v189, 0
  v_mov_b32 v190, 0
  v_mov_b32 v191, 0
  v_mov_b32 v192, 0
  v_mov_b32 v193, 0
  v_mov_b32 v194, 0
  v_mov_b32 v195, 0
  v_mov_b32 v196, 0
  v_mov_b32 v197, 0
  v_mov_b32 v198, 0
  v_mov_b32 v199, 0
  v_mov_b32 v200, 0
  v_mov_b32 v201, 0
  v_mov_b32 v202, 0
  v_mov_b32 v203, 0
  v_mov_b32 v204, 0
  v_mov_b32 v205, 0
  v_mov_b32 v206, 0
  v_mov_b32 v207, 0
  v_mov_b32 v208, 0
  v_mov_b32 v209, 0
  v_mov_b32 v210, 0
  v_mov_b32 v211, 0
  v_mov_b32 v212, 0
  v_mov_b32 v213, 0
  v_mov_b32 v214, 0
  v_mov_b32 v215, 0
  v_mov_b32 v216, 0
  v_mov_b32 v217, 0
  v_mov_b32 v218, 0
  v_mov_b32 v219, 0
  v_mov_b32 v220, 0
  v_mov_b32 v221, 0
  v_mov_b32 v222, 0
  v_mov_b32 v223, 0
  v_mov_b32 v224, 0
  v_mov_b32 v225, 0
  v_mov_b32 v226, 0
  v_mov_b32 v227, 0
  v_mov_b32 v228, 0
  v_mov_b32 v229, 0
  v_mov_b32 v230, 0
  v_mov_b32 v231, 0
  v_mov_b32 v232, 0
  v_mov_b32 v233, 0
  v_mov_b32 v234, 0
  v_mov_b32 v235, 0
  v_mov_b32 v236, 0
  v_mov_b32 v237, 0
  v_mov_b32 v238, 0
  v_mov_b32 v239, 0
  v_lshrrev_b32 v5, 1, v3
  v_xor_b32 v5, v5, v4
  v_lshlrev_b32 v5, 4, v5
  v_lshl_add_u32 v5, v3, 7, v5
  s_lshl_b32 s30, s28, 13
  v_add_u32 v8, s30, v5
  v_xor_b32 v9, 64, v8
  v_lshrrev_b32 v5, 2, v3
  v_and_b32 v6, 3, v3
  v_lshl_add_u32 v7, v4, 3, v5
  v_mul_u32_u24 v7, 448, v7
  v_lshl_add_u32 v7, v6, 3, v7
  v_add_u32 v7, 16384, v7
  s_mul_i32 s30, s29, 224
  v_and_b32 v5, 1, v4
  v_lshlrev_b32 v5, 5, v5
  v_add_u32 v7, s30, v7
  v_add_u32 v10, v7, v5
  v_sub_u32 v11, v7, v5
  s_cmp_eq_u32 s29, 1
  s_cbranch_scc0 G1_NOSW
  v_mov_b32 v12, v10
  v_mov_b32 v10, v11
  v_mov_b32 v11, v12
G1_NOSW:
  v_cmp_gt_u32 vcc, 128, v0
  s_and_saveexec_b64 s[44:45], vcc
  v_add_u32 v5, s26, v0
  v_mul_u32_u24 v5, 88, v5
  buffer_load_dwordx2 v[16:17], v5, s[36:39], 0 offen offset:0
  buffer_load_dwordx2 v[18:19], v5, s[36:39], 0 offen offset:8
  buffer_load_dwordx2 v[20:21], v5, s[36:39], 0 offen offset:16
  buffer_load_dwordx2 v[22:23], v5, s[36:39], 0 offen offset:24
  buffer_load_dwordx2 v[24:25], v5, s[36:39], 0 offen offset:32
  buffer_load_dwordx2 v[26:27], v5, s[36:39], 0 offen offset:40
  buffer_load_dwordx2 v[28:29], v5, s[36:39], 0 offen offset:48
  buffer_load_dwordx2 v[30:31], v5, s[36:39], 0 offen offset:56
  buffer_load_dwordx2 v[32:33], v5, s[36:39], 0 offen offset:64
  buffer_load_dwordx2 v[34:35], v5, s[36:39], 0 offen offset:72
  buffer_load_dwordx2 v[36:37], v5, s[36:39], 0 offen offset:80
  s_mov_b64 exec, s[44:45]
  v_cmp_gt_u32 vcc, 224, v0
  s_and_saveexec_b64 s[44:45], vcc
  v_add_u32 v6, s27, v0
  v_lshlrev_b32 v6, 2, v6
  s_mov_b32 s30, 0
  buffer_load_dword v40, v6, s[40:43], s30 offen
  s_mov_b32 s30, 14336
  buffer_load_dword v41, v6, s[40:43], s30 offen
  s_mov_b32 s30, 28672
  buffer_load_dword v42, v6, s[40:43], s30 offen
  s_mov_b32 s30, 43008
  buffer_load_dword v43, v6, s[40:43], s30 offen
  s_mov_b32 s30, 57344
  buffer_load_dword v44, v6, s[40:43], s30 offen
  s_mov_b32 s30, 71680
  buffer_load_dword v45, v6, s[40:43], s30 offen
  s_mov_b32 s30, 86016
  buffer_load_dword v46, v6, s[40:43], s30 offen
  s_mov_b32 s30, 100352
  buffer_load_dword v47, v6, s[40:43], s30 offen
  s_mov_b32 s30, 114688
  buffer_load_dword v48, v6, s[40:43], s30 offen
  s_mov_b32 s30, 129024
  buffer_load_dword v49, v6, s[40:43], s30 offen
  s_mov_b32 s30, 143360
  buffer_load_dword v50, v6, s[40:43], s30 offen
  s_mov_b32 s30, 157696
  buffer_load_dword v51, v6, s[40:43], s30 offen
  s_mov_b32 s30, 172032
  buffer_load_dword v52, v6, s[40:43], s30 offen
  s_mov_b32 s30, 186368
  buffer_load_dword v53, v6, s[40:43], s30 offen
  s_mov_b32 s30, 200704
  buffer_load_dword v54, v6, s[40:43], s30 offen
  s_mov_b32 s30, 215040
  buffer_load_dword v55, v6, s[40:43], s30 offen
  s_waitcnt vmcnt(0)
  v_add_f32 v40, v40, v41
  v_add_f32 v40, v40, v42
  v_add_f32 v40, v40, v43
  v_add_f32 v40, v40, v44
  v_add_f32 v40, v40, v45
  v_add_f32 v40, v40, v46
  v_add_f32 v40, v40, v47
  v_add_f32 v40, v40, v48
  v_add_f32 v40, v40, v49
  v_add_f32 v40, v40, v50
  v_add_f32 v40, v40, v51
  v_add_f32 v40, v40, v52
  v_add_f32 v40, v40, v53
  v_add_f32 v40, v40, v54
  v_add_f32 v40, v40, v55
  v_lshlrev_b32 v6, 2, v0
  v_add_u32 v6, 136192, v6
  ds_write_b32 v6, v40
  s_mov_b64 exec, s[44:45]
  v_cmp_gt_u32 vcc, 128, v0
  s_and_saveexec_b64 s[44:45], vcc
  s_waitcnt vmcnt(0)
  v_add_f32 v16, v16, v18
  v_add_f32 v17, v17, v19
  v_add_f32 v16, v16, v20
  v_add_f32 v17, v17, v21
  v_add_f32 v16, v16, v22
  v_add_f32 v17, v17, v23
  v_add_f32 v16, v16, v24
  v_add_f32 v17, v17, v25
  v_add_f32 v16, v16, v26
  v_add_f32 v17, v17, v27
  v_add_f32 v16, v16, v28
  v_add_f32 v17, v17, v29
  v_add_f32 v16, v16, v30
  v_add_f32 v17, v17, v31
  v_add_f32 v16, v16, v32
  v_add_f32 v17, v17, v33
  v_add_f32 v16, v16, v34
  v_add_f32 v17, v17, v35
  v_add_f32 v16, v16, v36
  v_add_f32 v17, v17, v37
  v_mul_f32 v16, 0x3a800000, v16
  v_mul_f32 v17, 0x3a800000, v17
  v_fma_f32 v17, -v16, v16, v17
  v_max_f32 v17, 0, v17
  v_add_f32 v17, 0x3727c5ac, v17
  v_rsq_f32 v17, v17
  v_lshlrev_b32 v6, 3, v0
  v_add_u32 v6, 135168, v6
  ds_write_b64 v6, v[16:17]
  s_mov_b64 exec, s[44:45]
  s_waitcnt lgkmcnt(0)
  s_barrier
  ds_read_b64_tr_b16 v[32:33], v10 offset:0
  ds_read_b64_tr_b16 v[34:35], v10 offset:1792
  ds_read_b128 v[16:19], v8 offset:0
  ds_read_b128 v[20:23], v8 offset:2048
  ds_read_b128 v[24:27], v8 offset:4096
  ds_read_b128 v[28:31], v8 offset:6144
  ds_read_b64_tr_b16 v[36:37], v11 offset:32
  ds_read_b64_tr_b16 v[38:39], v11 offset:1824
  ds_read_b64_tr_b16 v[40:41], v10 offset:64
  ds_read_b64_tr_b16 v[42:43], v10 offset:1856
  ds_read_b64_tr_b16 v[44:45], v11 offset:96
  ds_read_b64_tr_b16 v[46:47], v11 offset:1888
  ds_read_b64_tr_b16 v[48:49], v10 offset:128
  ds_read_b64_tr_b16 v[50:51], v10 offset:1920
  ds_read_b64_tr_b16 v[52:53], v11 offset:160
  ds_read_b64_tr_b16 v[54:55], v11 offset:1952
  ds_read_b64_tr_b16 v[56:57], v10 offset:192
  ds_read_b64_tr_b16 v[58:59], v10 offset:1984
  s_mov_b32 s32, 0
  s_mov_b32 s33, 15
G1_LOOP:
  s_waitcnt lgkmcnt(0)
  v_mfma_f32_16x16x32_bf16 v[128:131], v[32:35], v[16:19], v[128:131]
  ds_read_b64_tr_b16 v[76:77], v10 offset:14336
  v_mfma_f32_16x16x32_bf16 v[132:135], v[32:35], v[20:23], v[132:135]
  ds_read_b64_tr_b16 v[78:79], v10 offset:16128
  v_mfma_f32_16x16x32_bf16 v[136:139], v[32:35], v[24:27], v[136:139]
  ds_read_b128 v[60:63], v9 offset:0
  v_mfma_f32_16x16x32_bf16 v[140:143], v[32:35], v[28:31], v[140:143]
  ds_read_b128 v[64:67], v9 offset:2048
  v_mfma_f32_16x16x32_bf16 v[144:147], v[36:39], v[16:19], v[144:147]
  ds_read_b128 v[68:71], v9 offset:4096
  v_mfma_f32_16x16x32_bf16 v[148:151], v[36:39], v[20:23], v[148:151]
  ds_read_b128 v[72:75], v9 offset:6144
  v_mfma_f32_16x16x32_bf16 v[152:155], v[36:39], v[24:27], v[152:155]
  ds_read_b64_tr_b16 v[80:81], v11 offset:14368
  v_mfma_f32_16x16x32_bf16 v[156:159], v[36:39], v[28:31], v[156:159]
  ds_read_b64_tr_b16 v[82:83], v11 offset:16160
  v_mfma_f32_16x16x32_bf16 v[160:163], v[40:43], v[16:19], v[160:163]
  ds_read_b64_tr_b16 v[84:85], v10 offset:14400
  v_mfma_f32_16x16x32_bf16 v[164:167], v[40:43], v[20:23], v[164:167]
  ds_read_b64_tr_b16 v[86:87], v10 offset:16192
  v_mfma_f32_16x16x32_bf16 v[168:171], v[40:43], v[24:27], v[168:171]
  ds_read_b64_tr_b16 v[88:89], v11 offset:14432
  v_mfma_f32_16x16x32_bf16 v[172:175], v[40:43], v[28:31], v[172:175]
  ds_read_b64_tr_b16 v[90:91], v11 offset:16224
  v_mfma_f32_16x16x32_bf16 v[176:179], v[44:47], v[16:19], v[176:179]
  ds_read_b64_tr_b16 v[92:93], v10 offset:14464
  v_mfma_f32_16x16x32_bf16 v[180:183], v[44:47], v[20:23], v[180:183]
  ds_read_b64_tr_b16 v[94:95], v10 offset:16256
  v_mfma_f32_16x16x32_bf16 v[184:187], v[44:47], v[24:27], v[184:187]
  ds_read_b64_tr_b16 v[96:97], v11 offset:14496
  v_mfma_f32_16x16x32_bf16 v[188:191], v[44:47], v[28:31], v[188:191]
  ds_read_b64_tr_b16 v[98:99], v11 offset:16288
  v_mfma_f32_16x16x32_bf16 v[192:195], v[48:51], v[16:19], v[192:195]
  ds_read_b64_tr_b16 v[100:101], v10 offset:14528
  v_mfma_f32_16x16x32_bf16 v[196:199], v[48:51], v[20:23], v[196:199]
  ds_read_b64_tr_b16 v[102:103], v10 offset:16320
  v_mfma_f32_16x16x32_bf16 v[200:203], v[48:51], v[24:27], v[200:203]
  v_mfma_f32_16x16x32_bf16 v[204:207], v[48:51], v[28:31], v[204:207]
  v_mfma_f32_16x16x32_bf16 v[208:211], v[52:55], v[16:19], v[208:211]
  v_mfma_f32_16x16x32_bf16 v[212:215], v[52:55], v[20:23], v[212:215]
  v_mfma_f32_16x16x32_bf16 v[216:219], v[52:55], v[24:27], v[216:219]
  v_mfma_f32_16x16x32_bf16 v[220:223], v[52:55], v[28:31], v[220:223]
  v_mfma_f32_16x16x32_bf16 v[224:227], v[56:59], v[16:19], v[224:227]
  v_mfma_f32_16x16x32_bf16 v[228:231], v[56:59], v[20:23], v[228:231]
  v_mfma_f32_16x16x32_bf16 v[232:235], v[56:59], v[24:27], v[232:235]
  v_mfma_f32_16x16x32_bf16 v[236:239], v[56:59], v[28:31], v[236:239]
  s_waitcnt lgkmcnt(0)
  s_barrier
  s_add_u32 s34, s32, 45056
  s_cmp_eq_u32 s34, 135168
  s_cselect_b32 s34, 0, s34
  s_sub_u32 s35, s34, s32
  s_mov_b32 s32, s34
  v_add_u32 v8, s35, v8
  v_add_u32 v9, s35, v9
  v_add_u32 v10, s35, v10
  v_add_u32 v11, s35, v11
  v_mfma_f32_16x16x32_bf16 v[128:131], v[76:79], v[60:63], v[128:131]
  ds_read_b64_tr_b16 v[32:33], v10 offset:0
  v_mfma_f32_16x16x32_bf16 v[132:135], v[76:79], v[64:67], v[132:135]
  ds_read_b64_tr_b16 v[34:35], v10 offset:1792
  v_mfma_f32_16x16x32_bf16 v[136:139], v[76:79], v[68:71], v[136:139]
  ds_read_b128 v[16:19], v8 offset:0
  v_mfma_f32_16x16x32_bf16 v[140:143], v[76:79], v[72:75], v[140:143]
  ds_read_b128 v[20:23], v8 offset:2048
  v_mfma_f32_16x16x32_bf16 v[144:147], v[80:83], v[60:63], v[144:147]
  ds_read_b128 v[24:27], v8 offset:4096
  v_mfma_f32_16x16x32_bf16 v[148:151], v[80:83], v[64:67], v[148:151]
  ds_read_b128 v[28:31], v8 offset:6144
  v_mfma_f32_16x16x32_bf16 v[152:155], v[80:83], v[68:71], v[152:155]
  ds_read_b64_tr_b16 v[36:37], v11 offset:32
  v_mfma_f32_16x16x32_bf16 v[156:159], v[80:83], v[72:75], v[156:159]
  ds_read_b64_tr_b16 v[38:39], v11 offset:1824
  v_mfma_f32_16x16x32_bf16 v[160:163], v[84:87], v[60:63], v[160:163]
  ds_read_b64_tr_b16 v[40:41], v10 offset:64
  v_mfma_f32_16x16x32_bf16 v[164:167], v[84:87], v[64:67], v[164:167]
  ds_read_b64_tr_b16 v[42:43], v10 offset:1856
  v_mfma_f32_16x16x32_bf16 v[168:171], v[84:87], v[68:71], v[168:171]
  ds_read_b64_tr_b16 v[44:45], v11 offset:96
  v_mfma_f32_16x16x32_bf16 v[172:175], v[84:87], v[72:75], v[172:175]
  ds_read_b64_tr_b16 v[46:47], v11 offset:1888
  v_mfma_f32_16x16x32_bf16 v[176:179], v[88:91], v[60:63], v[176:179]
  ds_read_b64_tr_b16 v[48:49], v10 offset:128
  v_mfma_f32_16x16x32_bf16 v[180:183], v[88:91], v[64:67], v[180:183]
  ds_read_b64_tr_b16 v[50:51], v10 offset:1920
  v_mfma_f32_16x16x32_bf16 v[184:187], v[88:91], v[68:71], v[184:187]
  ds_read_b64_tr_b16 v[52:53], v11 offset:160
  v_mfma_f32_16x16x32_bf16 v[188:191], v[88:91], v[72:75], v[188:191]
  ds_read_b64_tr_b16 v[54:55], v11 offset:1952
  v_mfma_f32_16x16x32_bf16 v[192:195], v[92:95], v[60:63], v[192:195]
  ds_read_b64_tr_b16 v[56:57], v10 offset:192
  v_mfma_f32_16x16x32_bf16 v[196:199], v[92:95], v[64:67], v[196:199]
  ds_read_b64_tr_b16 v[58:59], v10 offset:1984
  v_mfma_f32_16x16x32_bf16 v[200:203], v[92:95], v[68:71], v[200:203]
  v_mfma_f32_16x16x32_bf16 v[204:207], v[92:95], v[72:75], v[204:207]
  v_mfma_f32_16x16x32_bf16 v[208:211], v[96:99], v[60:63], v[208:211]
  v_mfma_f32_16x16x32_bf16 v[212:215], v[96:99], v[64:67], v[212:215]
  v_mfma_f32_16x16x32_bf16 v[216:219], v[96:99], v[68:71], v[216:219]
  v_mfma_f32_16x16x32_bf16 v[220:223], v[96:99], v[72:75], v[220:223]
  v_mfma_f32_16x16x32_bf16 v[224:227], v[100:103], v[60:63], v[224:227]
  v_mfma_f32_16x16x32_bf16 v[228:231], v[100:103], v[64:67], v[228:231]
  v_mfma_f32_16x16x32_bf16 v[232:235], v[100:103], v[68:71], v[232:235]
  v_mfma_f32_16x16x32_bf16 v[236:239], v[100:103], v[72:75], v[236:239]
  s_sub_u32 s33, s33, 1
  s_cmp_lg_u32 s33, 0
  s_cbranch_scc1 G1_LOOP
  s_waitcnt lgkmcnt(0)
  v_mfma_f32_16x16x32_bf16 v[128:131], v[32:35], v[16:19], v[128:131]
  ds_read_b64_tr_b16 v[76:77], v10 offset:14336
  v_mfma_f32_16x16x32_bf16 v[132:135], v[32:35], v[20:23], v[132:135]
  ds_read_b64_tr_b16 v[78:79], v10 offset:16128
  v_mfma_f32_16x16x32_bf16 v[136:139], v[32:35], v[24:27], v[136:139]
  ds_read_b128 v[60:63], v9 offset:0
  v_mfma_f32_16x16x32_bf16 v[140:143], v[32:35], v[28:31], v[140:143]
  ds_read_b128 v[64:67], v9 offset:2048
  v_mfma_f32_16x16x32_bf16 v[144:147], v[36:39], v[16:19], v[144:147]
  ds_read_b128 v[68:71], v9 offset:4096
  v_mfma_f32_16x16x32_bf16 v[148:151], v[36:39], v[20:23], v[148:151]
  ds_read_b128 v[72:75], v9 offset:6144
  v_mfma_f32_16x16x32_bf16 v[152:155], v[36:39], v[24:27], v[152:155]
  ds_read_b64_tr_b16 v[80:81], v11 offset:14368
  v_mfma_f32_16x16x32_bf16 v[156:159], v[36:39], v[28:31], v[156:159]
  ds_read_b64_tr_b16 v[82:83], v11 offset:16160
  v_mfma_f32_16x16x32_bf16 v[160:163], v[40:43], v[16:19], v[160:163]
  ds_read_b64_tr_b16 v[84:85], v10 offset:14400
  v_mfma_f32_16x16x32_bf16 v[164:167], v[40:43], v[20:23], v[164:167]
  ds_read_b64_tr_b16 v[86:87], v10 offset:16192
  v_mfma_f32_16x16x32_bf16 v[168:171], v[40:43], v[24:27], v[168:171]
  ds_read_b64_tr_b16 v[88:89], v11 offset:14432
  v_mfma_f32_16x16x32_bf16 v[172:175], v[40:43], v[28:31], v[172:175]
  ds_read_b64_tr_b16 v[90:91], v11 offset:16224
  v_mfma_f32_16x16x32_bf16 v[176:179], v[44:47], v[16:19], v[176:179]
  ds_read_b64_tr_b16 v[92:93], v10 offset:14464
  v_mfma_f32_16x16x32_bf16 v[180:183], v[44:47], v[20:23], v[180:183]
  ds_read_b64_tr_b16 v[94:95], v10 offset:16256
  v_mfma_f32_16x16x32_bf16 v[184:187], v[44:47], v[24:27], v[184:187]
  ds_read_b64_tr_b16 v[96:97], v11 offset:14496
  v_mfma_f32_16x16x32_bf16 v[188:191], v[44:47], v[28:31], v[188:191]
  ds_read_b64_tr_b16 v[98:99], v11 offset:16288
  v_mfma_f32_16x16x32_bf16 v[192:195], v[48:51], v[16:19], v[192:195]
  ds_read_b64_tr_b16 v[100:101], v10 offset:14528
  v_mfma_f32_16x16x32_bf16 v[196:199], v[48:51], v[20:23], v[196:199]
  ds_read_b64_tr_b16 v[102:103], v10 offset:16320
  v_mfma_f32_16x16x32_bf16 v[200:203], v[48:51], v[24:27], v[200:203]
  v_mfma_f32_16x16x32_bf16 v[204:207], v[48:51], v[28:31], v[204:207]
  v_mfma_f32_16x16x32_bf16 v[208:211], v[52:55], v[16:19], v[208:211]
  v_mfma_f32_16x16x32_bf16 v[212:215], v[52:55], v[20:23], v[212:215]
  v_mfma_f32_16x16x32_bf16 v[216:219], v[52:55], v[24:27], v[216:219]
  v_mfma_f32_16x16x32_bf16 v[220:223], v[52:55], v[28:31], v[220:223]
  v_mfma_f32_16x16x32_bf16 v[224:227], v[56:59], v[16:19], v[224:227]
  v_mfma_f32_16x16x32_bf16 v[228:231], v[56:59], v[20:23], v[228:231]
  v_mfma_f32_16x16x32_bf16 v[232:235], v[56:59], v[24:27], v[232:235]
  v_mfma_f32_16x16x32_bf16 v[236:239], v[56:59], v[28:31], v[236:239]
  s_waitcnt lgkmcnt(0)
  v_mfma_f32_16x16x32_bf16 v[128:131], v[76:79], v[60:63], v[128:131]
  v_mfma_f32_16x16x32_bf16 v[132:135], v[76:79], v[64:67], v[132:135]
  v_mfma_f32_16x16x32_bf16 v[136:139], v[76:79], v[68:71], v[136:139]
  v_mfma_f32_16x16x32_bf16 v[140:143], v[76:79], v[72:75], v[140:143]
  v_mfma_f32_16x16x32_bf16 v[144:147], v[80:83], v[60:63], v[144:147]
  v_mfma_f32_16x16x32_bf16 v[148:151], v[80:83], v[64:67], v[148:151]
  v_mfma_f32_16x16x32_bf16 v[152:155], v[80:83], v[68:71], v[152:155]
  v_mfma_f32_16x16x32_bf16 v[156:159], v[80:83], v[72:75], v[156:159]
  v_mfma_f32_16x16x32_bf16 v[160:163], v[84:87], v[60:63], v[160:163]
  v_mfma_f32_16x16x32_bf16 v[164:167], v[84:87], v[64:67], v[164:167]
  v_mfma_f32_16x16x32_bf16 v[168:171], v[84:87], v[68:71], v[168:171]
  v_mfma_f32_16x16x32_bf16 v[172:175], v[84:87], v[72:75], v[172:175]
  v_mfma_f32_16x16x32_bf16 v[176:179], v[88:91], v[60:63], v[176:179]
  v_mfma_f32_16x16x32_bf16 v[180:183], v[88:91], v[64:67], v[180:183]
  v_mfma_f32_16x16x32_bf16 v[184:187], v[88:91], v[68:71], v[184:187]
  v_mfma_f32_16x16x32_bf16 v[188:191], v[88:91], v[72:75], v[188:191]
  v_mfma_f32_16x16x32_bf16 v[192:195], v[92:95], v[60:63], v[192:195]
  v_mfma_f32_16x16x32_bf16 v[196:199], v[92:95], v[64:67], v[196:199]
  v_mfma_f32_16x16x32_bf16 v[200:203], v[92:95], v[68:71], v[200:203]
  v_mfma_f32_16x16x32_bf16 v[204:207], v[92:95], v[72:75], v[204:207]
  v_mfma_f32_16x16x32_bf16 v[208:211], v[96:99], v[60:63], v[208:211]
  v_mfma_f32_16x16x32_bf16 v[212:215], v[96:99], v[64:67], v[212:215]
  v_mfma_f32_16x16x32_bf16 v[216:219], v[96:99], v[68:71], v[216:219]
  v_mfma_f32_16x16x32_bf16 v[220:223], v[96:99], v[72:75], v[220:223]
  v_mfma_f32_16x16x32_bf16 v[224:227], v[100:103], v[60:63], v[224:227]
  v_mfma_f32_16x16x32_bf16 v[228:231], v[100:103], v[64:67], v[228:231]
  v_mfma_f32_16x16x32_bf16 v[232:235], v[100:103], v[68:71], v[232:235]
  v_mfma_f32_16x16x32_bf16 v[236:239], v[100:103], v[72:75], v[236:239]
  s_nop 7
  s_nop 1
  s_lshl_b32 s30, s28, 6
  v_add_u32 v5, s30, v3
  v_lshlrev_b32 v6, 3, v5
  v_add_u32 v6, 135168, v6
  ds_read_b64 v[16:17], v6 offset:0
  ds_read_b64 v[18:19], v6 offset:128
  ds_read_b64 v[20:21], v6 offset:256
  ds_read_b64 v[22:23], v6 offset:384
  s_mul_i32 s31, s29, 448
  v_lshlrev_b32 v7, 4, v4
  v_add_u32 v7, s31, v7
  v_add_u32 v7, 136192, v7
  ds_read_b128 v[24:27], v7 offset:0
  ds_read_b128 v[28:31], v7 offset:64
  ds_read_b128 v[32:35], v7 offset:128
  ds_read_b128 v[36:39], v7 offset:192
  ds_read_b128 v[40:43], v7 offset:256
  ds_read_b128 v[44:47], v7 offset:320
  ds_read_b128 v[48:51], v7 offset:384
  s_mul_i32 s31, s3, 15360
  s_add_u32 s31, s31, 45056
  v_mul_u32_u24 v8, 240, v3
  v_lshl_add_u32 v8, v4, 3, v8
  v_add_u32 v8, s31, v8
  s_waitcnt lgkmcnt(0)
  v_mul_f32 v16, v16, v17
  v_mul_f32 v18, v18, v19
  v_mul_f32 v20, v20, v21
  v_mul_f32 v22, v22, v23
  v_mov_b32 v15, 0
  v_pk_mul_f32 v[128:129], v[128:129], v[16:17] op_sel:[0,1] op_sel_hi:[1,1]
  v_pk_mul_f32 v[130:131], v[130:131], v[16:17] op_sel:[0,1] op_sel_hi:[1,1]
  v_pk_fma_f32 v[128:129], v[24:25], v[16:17], v[128:129] op_sel:[0,0,0] op_sel_hi:[1,0,1] neg_lo:[0,1,0] neg_hi:[0,1,0]
  v_pk_fma_f32 v[130:131], v[26:27], v[16:17], v[130:131] op_sel:[0,0,0] op_sel_hi:[1,0,1] neg_lo:[0,1,0] neg_hi:[0,1,0]
  v_cvt_pk_bf16_f32 v56, v128, v129
  v_cvt_pk_bf16_f32 v57, v130, v131
  v_pk_max_i16 v56, v56, v15
  v_pk_max_i16 v57, v57, v15
  ds_write_b64 v8, v[56:57] offset:0
  v_pk_mul_f32 v[144:145], v[144:145], v[16:17] op_sel:[0,1] op_sel_hi:[1,1]
  v_pk_mul_f32 v[146:147], v[146:147], v[16:17] op_sel:[0,1] op_sel_hi:[1,1]
  v_pk_fma_f32 v[144:145], v[28:29], v[16:17], v[144:145] op_sel:[0,0,0] op_sel_hi:[1,0,1] neg_lo:[0,1,0] neg_hi:[0,1,0]
  v_pk_fma_f32 v[146:147], v[30:31], v[16:17], v[146:147] op_sel:[0,0,0] op_sel_hi:[1,0,1] neg_lo:[0,1,0] neg_hi:[0,1,0]
  v_cvt_pk_bf16_f32 v58, v144, v145
  v_cvt_pk_bf16_f32 v59, v146, v147
  v_pk_max_i16 v58, v58, v15
  v_pk_max_i16 v59, v59, v15
  ds_write_b64 v8, v[58:59] offset:32
  v_pk_mul_f32 v[160:161], v[160:161], v[16:17] op_sel:[0,1] op_sel_hi:[1,1]
  v_pk_mul_f32 v[162:163], v[162:163], v[16:17] op_sel:[0,1] op_sel_hi:[1,1]
  v_pk_fma_f32 v[160:161], v[32:33], v[16:17], v[160:161] op_sel:[0,0,0] op_sel_hi:[1,0,1] neg_lo:[0,1,0] neg_hi:[0,1,0]
  v_pk_fma_f32 v[162:163], v[34:35], v[16:17], v[162:163] op_sel:[0,0,0] op_sel_hi:[1,0,1] neg_lo:[0,1,0] neg_hi:[0,1,0]
  v_cvt_pk_bf16_f32 v60, v160, v161
  v_cvt_pk_bf16_f32 v61, v162, v163
  v_pk_max_i16 v60, v60, v15
  v_pk_max_i16 v61, v61, v15
  ds_write_b64 v8, v[60:61] offset:64
  v_pk_mul_f32 v[176:177], v[176:177], v[16:17] op_sel:[0,1] op_sel_hi:[1,1]
  v_pk_mul_f32 v[178:179], v[178:179], v[16:17] op_sel:[0,1] op_sel_hi:[1,1]
  v_pk_fma_f32 v[176:177], v[36:37], v[16:17], v[176:177] op_sel:[0,0,0] op_sel_hi:[1,0,1] neg_lo:[0,1,0] neg_hi:[0,1,0]
  v_pk_fma_f32 v[178:179], v[38:39], v[16:17], v[178:179] op_sel:[0,0,0] op_sel_hi:[1,0,1] neg_lo:[0,1,0] neg_hi:[0,1,0]
  v_cvt_pk_bf16_f32 v62, v176, v177
  v_cvt_pk_bf16_f32 v63, v178, v179
  v_pk_max_i16 v62, v62, v15
  v_pk_max_i16 v63, v63, v15
  ds_write_b64 v8, v[62:63] offset:96
  v_pk_mul_f32 v[192:193], v[192:193], v[16:17] op_sel:[0,1] op_sel_hi:[1,1]
  v_pk_mul_f32 v[194:195], v[194:195], v[16:17] op_sel:[0,1] op_sel_hi:[1,1]
  v_pk_fma_f32 v[192:193], v[40:41], v[16:17], v[192:193] op_sel:[0,0,0] op_sel_hi:[1,0,1] neg_lo:[0,1,0] neg_hi:[0,1,0]
  v_pk_fma_f32 v[194:195], v[42:43], v[16:17], v[194:195] op_sel:[0,0,0] op_sel_hi:[1,0,1] neg_lo:[0,1,0] neg_hi:[0,1,0]
  v_cvt_pk_bf16_f32 v64, v192, v193
  v_cvt_pk_bf16_f32 v65, v194, v195
  v_pk_max_i16 v64, v64, v15
  v_pk_max_i16 v65, v65, v15
  ds_write_b64 v8, v[64:65] offset:128
  v_pk_mul_f32 v[208:209], v[208:209], v[16:17] op_sel:[0,1] op_sel_hi:[1,1]
  v_pk_mul_f32 v[210:211], v[210:211], v[16:17] op_sel:[0,1] op_sel_hi:[1,1]
  v_pk_fma_f32 v[208:209], v[44:45], v[16:17], v[208:209] op_sel:[0,0,0] op_sel_hi:[1,0,1] neg_lo:[0,1,0] neg_hi:[0,1,0]
  v_pk_fma_f32 v[210:211], v[46:47], v[16:17], v[210:211] op_sel:[0,0,0] op_sel_hi:[1,0,1] neg_lo:[0,1,0] neg_hi:[0,1,0]
  v_cvt_pk_bf16_f32 v66, v208, v209
  v_cvt_pk_bf16_f32 v67, v210, v211
  v_pk_max_i16 v66, v66, v15
  v_pk_max_i16 v67, v67, v15
  ds_write_b64 v8, v[66:67] offset:160
  v_pk_mul_f32 v[224:225], v[224:225], v[16:17] op_sel:[0,1] op_sel_hi:[1,1]
  v_pk_mul_f32 v[226:227], v[226:227], v[16:17] op_sel:[0,1] op_sel_hi:[1,1]
  v_pk_fma_f32 v[224:225], v[48:49], v[16:17], v[224:225] op_sel:[0,0,0] op_sel_hi:[1,0,1] neg_lo:[0,1,0] neg_hi:[0,1,0]
  v_pk_fma_f32 v[226:227], v[50:51], v[16:17], v[226:227] op_sel:[0,0,0] op_sel_hi:[1,0,1] neg_lo:[0,1,0] neg_hi:[0,1,0]
  v_cvt_pk_bf16_f32 v68, v224, v225
  v_cvt_pk_bf16_f32 v69, v226, v227
  v_pk_max_i16 v68, v68, v15
  v_pk_max_i16 v69, v69, v15
  ds_write_b64 v8, v[68:69] offset:192
  v_pk_mul_f32 v[132:133], v[132:133], v[18:19] op_sel:[0,1] op_sel_hi:[1,1]
  v_pk_mul_f32 v[134:135], v[134:135], v[18:19] op_sel:[0,1] op_sel_hi:[1,1]
  v_pk_fma_f32 v[132:133], v[24:25], v[18:19], v[132:133] op_sel:[0,0,0] op_sel_hi:[1,0,1] neg_lo:[0,1,0] neg_hi:[0,1,0]
  v_pk_fma_f32 v[134:135], v[26:27], v[18:19], v[134:135] op_sel:[0,0,0] op_sel_hi:[1,0,1] neg_lo:[0,1,0] neg_hi:[0,1,0]
  v_cvt_pk_bf16_f32 v70, v132, v133
  v_cvt_pk_bf16_f32 v71, v134, v135
  v_pk_max_i16 v70, v70, v15
  v_pk_max_i16 v71, v71, v15
  ds_write_b64 v8, v[70:71] offset:3840
  v_pk_mul_f32 v[148:149], v[148:149], v[18:19] op_sel:[0,1] op_sel_hi:[1,1]
  v_pk_mul_f32 v[150:151], v[150:151], v[18:19] op_sel:[0,1] op_sel_hi:[1,1]
  v_pk_fma_f32 v[148:149], v[28:29], v[18:19], v[148:149] op_sel:[0,0,0] op_sel_hi:[1,0,1] neg_lo:[0,1,0] neg_hi:[0,1,0]
  v_pk_fma_f32 v[150:151], v[30:31], v[18:19], v[150:151] op_sel:[0,0,0] op_sel_hi:[1,0,1] neg_lo:[0,1,0] neg_hi:[0,1,0]
  v_cvt_pk_bf16_f32 v56, v148, v149
  v_cvt_pk_bf16_f32 v57, v150, v151
  v_pk_max_i16 v56, v56, v15
  v_pk_max_i16 v57, v57, v15
  ds_write_b64 v8, v[56:57] offset:3872
  v_pk_mul_f32 v[164:165], v[164:165], v[18:19] op_sel:[0,1] op_sel_hi:[1,1]
  v_pk_mul_f32 v[166:167], v[166:167], v[18:19] op_sel:[0,1] op_sel_hi:[1,1]
  v_pk_fma_f32 v[164:165], v[32:33], v[18:19], v[164:165] op_sel:[0,0,0] op_sel_hi:[1,0,1] neg_lo:[0,1,0] neg_hi:[0,1,0]
  v_pk_fma_f32 v[166:167], v[34:35], v[18:19], v[166:167] op_sel:[0,0,0] op_sel_hi:[1,0,1] neg_lo:[0,1,0] neg_hi:[0,1,0]
  v_cvt_pk_bf16_f32 v58, v164, v165
  v_cvt_pk_bf16_f32 v59, v166, v167
  v_pk_max_i16 v58, v58, v15
  v_pk_max_i16 v59, v59, v15
  ds_write_b64 v8, v[58:59] offset:3904
  v_pk_mul_f32 v[180:181], v[180:181], v[18:19] op_sel:[0,1] op_sel_hi:[1,1]
  v_pk_mul_f32 v[182:183], v[182:183], v[18:19] op_sel:[0,1] op_sel_hi:[1,1]
  v_pk_fma_f32 v[180:181], v[36:37], v[18:19], v[180:181] op_sel:[0,0,0] op_sel_hi:[1,0,1] neg_lo:[0,1,0] neg_hi:[0,1,0]
  v_pk_fma_f32 v[182:183], v[38:39], v[18:19], v[182:183] op_sel:[0,0,0] op_sel_hi:[1,0,1] neg_lo:[0,1,0] neg_hi:[0,1,0]
  v_cvt_pk_bf16_f32 v60, v180, v181
  v_cvt_pk_bf16_f32 v61, v182, v183
  v_pk_max_i16 v60, v60, v15
  v_pk_max_i16 v61, v61, v15
  ds_write_b64 v8, v[60:61] offset:3936
  v_pk_mul_f32 v[196:197], v[196:197], v[18:19] op_sel:[0,1] op_sel_hi:[1,1]
  v_pk_mul_f32 v[198:199], v[198:199], v[18:19] op_sel:[0,1] op_sel_hi:[1,1]
  v_pk_fma_f32 v[196:197], v[40:41], v[18:19], v[196:197] op_sel:[0,0,0] op_sel_hi:[1,0,1] neg_lo:[0,1,0] neg_hi:[0,1,0]
  v_pk_fma_f32 v[198:199], v[42:43], v[18:19], v[198:199] op_sel:[0,0,0] op_sel_hi:[1,0,1] neg_lo:[0,1,0] neg_hi:[0,1,0]
  v_cvt_pk_bf16_f32 v62, v196, v197
  v_cvt_pk_bf16_f32 v63, v198, v199
  v_pk_max_i16 v62, v62, v15
  v_pk_max_i16 v63, v63, v15
  ds_write_b64 v8, v[62:63] offset:3968
  v_pk_mul_f32 v[212:213], v[212:213], v[18:19] op_sel:[0,1] op_sel_hi:[1,1]
  v_pk_mul_f32 v[214:215], v[214:215], v[18:19] op_sel:[0,1] op_sel_hi:[1,1]
  v_pk_fma_f32 v[212:213], v[44:45], v[18:19], v[212:213] op_sel:[0,0,0] op_sel_hi:[1,0,1] neg_lo:[0,1,0] neg_hi:[0,1,0]
  v_pk_fma_f32 v[214:215], v[46:47], v[18:19], v[214:215] op_sel:[0,0,0] op_sel_hi:[1,0,1] neg_lo:[0,1,0] neg_hi:[0,1,0]
  v_cvt_pk_bf16_f32 v64, v212, v213
  v_cvt_pk_bf16_f32 v65, v214, v215
  v_pk_max_i16 v64, v64, v15
  v_pk_max_i16 v65, v65, v15
  ds_write_b64 v8, v[64:65] offset:4000
  v_pk_mul_f32 v[228:229], v[228:229], v[18:19] op_sel:[0,1] op_sel_hi:[1,1]
  v_pk_mul_f32 v[230:231], v[230:231], v[18:19] op_sel:[0,1] op_sel_hi:[1,1]
  v_pk_fma_f32 v[228:229], v[48:49], v[18:19], v[228:229] op_sel:[0,0,0] op_sel_hi:[1,0,1] neg_lo:[0,1,0] neg_hi:[0,1,0]
  v_pk_fma_f32 v[230:231], v[50:51], v[18:19], v[230:231] op_sel:[0,0,0] op_sel_hi:[1,0,1] neg_lo:[0,1,0] neg_hi:[0,1,0]
  v_cvt_pk_bf16_f32 v66, v228, v229
  v_cvt_pk_bf16_f32 v67, v230, v231
  v_pk_max_i16 v66, v66, v15
  v_pk_max_i16 v67, v67, v15
  ds_write_b64 v8, v[66:67] offset:4032
  v_pk_mul_f32 v[136:137], v[136:137], v[20:21] op_sel:[0,1] op_sel_hi:[1,1]
  v_pk_mul_f32 v[138:139], v[138:139], v[20:21] op_sel:[0,1] op_sel_hi:[1,1]
  v_pk_fma_f32 v[136:137], v[24:25], v[20:21], v[136:137] op_sel:[0,0,0] op_sel_hi:[1,0,1] neg_lo:[0,1,0] neg_hi:[0,1,0]
  v_pk_fma_f32 v[138:139], v[26:27], v[20:21], v[138:139] op_sel:[0,0,0] op_sel_hi:[1,0,1] neg_lo:[0,1,0] neg_hi:[0,1,0]
  v_cvt_pk_bf16_f32 v68, v136, v137
  v_cvt_pk_bf16_f32 v69, v138, v139
  v_pk_max_i16 v68, v68, v15
  v_pk_max_i16 v69, v69, v15
  ds_write_b64 v8, v[68:69] offset:7680
  v_pk_mul_f32 v[152:153], v[152:153], v[20:21] op_sel:[0,1] op_sel_hi:[1,1]
  v_pk_mul_f32 v[154:155], v[154:155], v[20:21] op_sel:[0,1] op_sel_hi:[1,1]
  v_pk_fma_f32 v[152:153], v[28:29], v[20:21], v[152:153] op_sel:[0,0,0] op_sel_hi:[1,0,1] neg_lo:[0,1,0] neg_hi:[0,1,0]
  v_pk_fma_f32 v[154:155], v[30:31], v[20:21], v[154:155] op_sel:[0,0,0] op_sel_hi:[1,0,1] neg_lo:[0,1,0] neg_hi:[0,1,0]
  v_cvt_pk_bf16_f32 v70, v152, v153
  v_cvt_pk_bf16_f32 v71, v154, v155
  v_pk_max_i16 v70, v70, v15
  v_pk_max_i16 v71, v71, v15
  ds_write_b64 v8, v[70:71] offset:7712
  v_pk_mul_f32 v[168:169], v[168:169], v[20:21] op_sel:[0,1] op_sel_hi:[1,1]
  v_pk_mul_f32 v[170:171], v[170:171], v[20:21] op_sel:[0,1] op_sel_hi:[1,1]
  v_pk_fma_f32 v[168:169], v[32:33], v[20:21], v[168:169] op_sel:[0,0,0] op_sel_hi:[1,0,1] neg_lo:[0,1,0] neg_hi:[0,1,0]
  v_pk_fma_f32 v[170:171], v[34:35], v[20:21], v[170:171] op_sel:[0,0,0] op_sel_hi:[1,0,1] neg_lo:[0,1,0] neg_hi:[0,1,0]
  v_cvt_pk_bf16_f32 v56, v168, v169
  v_cvt_pk_bf16_f32 v57, v170, v171
  v_pk_max_i16 v56, v56, v15
  v_pk_max_i16 v57, v57, v15
  ds_write_b64 v8, v[56:57] offset:7744
  v_pk_mul_f32 v[184:185], v[184:185], v[20:21] op_sel:[0,1] op_sel_hi:[1,1]
  v_pk_mul_f32 v[186:187], v[186:187], v[20:21] op_sel:[0,1] op_sel_hi:[1,1]
  v_pk_fma_f32 v[184:185], v[36:37], v[20:21], v[184:185] op_sel:[0,0,0] op_sel_hi:[1,0,1] neg_lo:[0,1,0] neg_hi:[0,1,0]
  v_pk_fma_f32 v[186:187], v[38:39], v[20:21], v[186:187] op_sel:[0,0,0] op_sel_hi:[1,0,1] neg_lo:[0,1,0] neg_hi:[0,1,0]
  v_cvt_pk_bf16_f32 v58, v184, v185
  v_cvt_pk_bf16_f32 v59, v186, v187
  v_pk_max_i16 v58, v58, v15
  v_pk_max_i16 v59, v59, v15
  ds_write_b64 v8, v[58:59] offset:7776
  v_pk_mul_f32 v[200:201], v[200:201], v[20:21] op_sel:[0,1] op_sel_hi:[1,1]
  v_pk_mul_f32 v[202:203], v[202:203], v[20:21] op_sel:[0,1] op_sel_hi:[1,1]
  v_pk_fma_f32 v[200:201], v[40:41], v[20:21], v[200:201] op_sel:[0,0,0] op_sel_hi:[1,0,1] neg_lo:[0,1,0] neg_hi:[0,1,0]
  v_pk_fma_f32 v[202:203], v[42:43], v[20:21], v[202:203] op_sel:[0,0,0] op_sel_hi:[1,0,1] neg_lo:[0,1,0] neg_hi:[0,1,0]
  v_cvt_pk_bf16_f32 v60, v200, v201
  v_cvt_pk_bf16_f32 v61, v202, v203
  v_pk_max_i16 v60, v60, v15
  v_pk_max_i16 v61, v61, v15
  ds_write_b64 v8, v[60:61] offset:7808
  v_pk_mul_f32 v[216:217], v[216:217], v[20:21] op_sel:[0,1] op_sel_hi:[1,1]
  v_pk_mul_f32 v[218:219], v[218:219], v[20:21] op_sel:[0,1] op_sel_hi:[1,1]
  v_pk_fma_f32 v[216:217], v[44:45], v[20:21], v[216:217] op_sel:[0,0,0] op_sel_hi:[1,0,1] neg_lo:[0,1,0] neg_hi:[0,1,0]
  v_pk_fma_f32 v[218:219], v[46:47], v[20:21], v[218:219] op_sel:[0,0,0] op_sel_hi:[1,0,1] neg_lo:[0,1,0] neg_hi:[0,1,0]
  v_cvt_pk_bf16_f32 v62, v216, v217
  v_cvt_pk_bf16_f32 v63, v218, v219
  v_pk_max_i16 v62, v62, v15
  v_pk_max_i16 v63, v63, v15
  ds_write_b64 v8, v[62:63] offset:7840
  v_pk_mul_f32 v[232:233], v[232:233], v[20:21] op_sel:[0,1] op_sel_hi:[1,1]
  v_pk_mul_f32 v[234:235], v[234:235], v[20:21] op_sel:[0,1] op_sel_hi:[1,1]
  v_pk_fma_f32 v[232:233], v[48:49], v[20:21], v[232:233] op_sel:[0,0,0] op_sel_hi:[1,0,1] neg_lo:[0,1,0] neg_hi:[0,1,0]
  v_pk_fma_f32 v[234:235], v[50:51], v[20:21], v[234:235] op_sel:[0,0,0] op_sel_hi:[1,0,1] neg_lo:[0,1,0] neg_hi:[0,1,0]
  v_cvt_pk_bf16_f32 v64, v232, v233
  v_cvt_pk_bf16_f32 v65, v234, v235
  v_pk_max_i16 v64, v64, v15
  v_pk_max_i16 v65, v65, v15
  ds_write_b64 v8, v[64:65] offset:7872
  v_pk_mul_f32 v[140:141], v[140:141], v[22:23] op_sel:[0,1] op_sel_hi:[1,1]
  v_pk_mul_f32 v[142:143], v[142:143], v[22:23] op_sel:[0,1] op_sel_hi:[1,1]
  v_pk_fma_f32 v[140:141], v[24:25], v[22:23], v[140:141] op_sel:[0,0,0] op_sel_hi:[1,0,1] neg_lo:[0,1,0] neg_hi:[0,1,0]
  v_pk_fma_f32 v[142:143], v[26:27], v[22:23], v[142:143] op_sel:[0,0,0] op_sel_hi:[1,0,1] neg_lo:[0,1,0] neg_hi:[0,1,0]
  v_cvt_pk_bf16_f32 v66, v140, v141
  v_cvt_pk_bf16_f32 v67, v142, v143
  v_pk_max_i16 v66, v66, v15
  v_pk_max_i16 v67, v67, v15
  ds_write_b64 v8, v[66:67] offset:11520
  v_pk_mul_f32 v[156:157], v[156:157], v[22:23] op_sel:[0,1] op_sel_hi:[1,1]
  v_pk_mul_f32 v[158:159], v[158:159], v[22:23] op_sel:[0,1] op_sel_hi:[1,1]
  v_pk_fma_f32 v[156:157], v[28:29], v[22:23], v[156:157] op_sel:[0,0,0] op_sel_hi:[1,0,1] neg_lo:[0,1,0] neg_hi:[0,1,0]
  v_pk_fma_f32 v[158:159], v[30:31], v[22:23], v[158:159] op_sel:[0,0,0] op_sel_hi:[1,0,1] neg_lo:[0,1,0] neg_hi:[0,1,0]
  v_cvt_pk_bf16_f32 v68, v156, v157
  v_cvt_pk_bf16_f32 v69, v158, v159
  v_pk_max_i16 v68, v68, v15
  v_pk_max_i16 v69, v69, v15
  ds_write_b64 v8, v[68:69] offset:11552
  v_pk_mul_f32 v[172:173], v[172:173], v[22:23] op_sel:[0,1] op_sel_hi:[1,1]
  v_pk_mul_f32 v[174:175], v[174:175], v[22:23] op_sel:[0,1] op_sel_hi:[1,1]
  v_pk_fma_f32 v[172:173], v[32:33], v[22:23], v[172:173] op_sel:[0,0,0] op_sel_hi:[1,0,1] neg_lo:[0,1,0] neg_hi:[0,1,0]
  v_pk_fma_f32 v[174:175], v[34:35], v[22:23], v[174:175] op_sel:[0,0,0] op_sel_hi:[1,0,1] neg_lo:[0,1,0] neg_hi:[0,1,0]
  v_cvt_pk_bf16_f32 v70, v172, v173
  v_cvt_pk_bf16_f32 v71, v174, v175
  v_pk_max_i16 v70, v70, v15
  v_pk_max_i16 v71, v71, v15
  ds_write_b64 v8, v[70:71] offset:11584
  v_pk_mul_f32 v[188:189], v[188:189], v[22:23] op_sel:[0,1] op_sel_hi:[1,1]
  v_pk_mul_f32 v[190:191], v[190:191], v[22:23] op_sel:[0,1] op_sel_hi:[1,1]
  v_pk_fma_f32 v[188:189], v[36:37], v[22:23], v[188:189] op_sel:[0,0,0] op_sel_hi:[1,0,1] neg_lo:[0,1,0] neg_hi:[0,1,0]
  v_pk_fma_f32 v[190:191], v[38:39], v[22:23], v[190:191] op_sel:[0,0,0] op_sel_hi:[1,0,1] neg_lo:[0,1,0] neg_hi:[0,1,0]
  v_cvt_pk_bf16_f32 v56, v188, v189
  v_cvt_pk_bf16_f32 v57, v190, v191
  v_pk_max_i16 v56, v56, v15
  v_pk_max_i16 v57, v57, v15
  ds_write_b64 v8, v[56:57] offset:11616
  v_pk_mul_f32 v[204:205], v[204:205], v[22:23] op_sel:[0,1] op_sel_hi:[1,1]
  v_pk_mul_f32 v[206:207], v[206:207], v[22:23] op_sel:[0,1] op_sel_hi:[1,1]
  v_pk_fma_f32 v[204:205], v[40:41], v[22:23], v[204:205] op_sel:[0,0,0] op_sel_hi:[1,0,1] neg_lo:[0,1,0] neg_hi:[0,1,0]
  v_pk_fma_f32 v[206:207], v[42:43], v[22:23], v[206:207] op_sel:[0,0,0] op_sel_hi:[1,0,1] neg_lo:[0,1,0] neg_hi:[0,1,0]
  v_cvt_pk_bf16_f32 v58, v204, v205
  v_cvt_pk_bf16_f32 v59, v206, v207
  v_pk_max_i16 v58, v58, v15
  v_pk_max_i16 v59, v59, v15
  ds_write_b64 v8, v[58:59] offset:11648
  v_pk_mul_f32 v[220:221], v[220:221], v[22:23] op_sel:[0,1] op_sel_hi:[1,1]
  v_pk_mul_f32 v[222:223], v[222:223], v[22:23] op_sel:[0,1] op_sel_hi:[1,1]
  v_pk_fma_f32 v[220:221], v[44:45], v[22:23], v[220:221] op_sel:[0,0,0] op_sel_hi:[1,0,1] neg_lo:[0,1,0] neg_hi:[0,1,0]
  v_pk_fma_f32 v[222:223], v[46:47], v[22:23], v[222:223] op_sel:[0,0,0] op_sel_hi:[1,0,1] neg_lo:[0,1,0] neg_hi:[0,1,0]
  v_cvt_pk_bf16_f32 v60, v220, v221
  v_cvt_pk_bf16_f32 v61, v222, v223
  v_pk_max_i16 v60, v60, v15
  v_pk_max_i16 v61, v61, v15
  ds_write_b64 v8, v[60:61] offset:11680
  v_pk_mul_f32 v[236:237], v[236:237], v[22:23] op_sel:[0,1] op_sel_hi:[1,1]
  v_pk_mul_f32 v[238:239], v[238:239], v[22:23] op_sel:[0,1] op_sel_hi:[1,1]
  v_pk_fma_f32 v[236:237], v[48:49], v[22:23], v[236:237] op_sel:[0,0,0] op_sel_hi:[1,0,1] neg_lo:[0,1,0] neg_hi:[0,1,0]
  v_pk_fma_f32 v[238:239], v[50:51], v[22:23], v[238:239] op_sel:[0,0,0] op_sel_hi:[1,0,1] neg_lo:[0,1,0] neg_hi:[0,1,0]
  v_cvt_pk_bf16_f32 v62, v236, v237
  v_cvt_pk_bf16_f32 v63, v238, v239
  v_pk_max_i16 v62, v62, v15
  v_pk_max_i16 v63, v63, v15
  ds_write_b64 v8, v[62:63] offset:11712
  s_lshl_b32 s30, s28, 6
  s_add_u32 s30, s30, s26
  s_mul_i32 s30, s30, 7168
  s_mul_i32 s34, s29, 112
  s_add_u32 s34, s34, s27
  s_lshl_b32 s34, s34, 1
  s_add_u32 s30, s30, s34
  s_add_u32 s35, s30, 229376
  v_add_u32 v9, 0, v1
  v_mul_u32_u24 v10, 4682, v9
  v_lshrrev_b32 v10, 16, v10
  v_mul_u32_u24 v11, 14, v10
  v_sub_u32 v9, v9, v11
  v_lshlrev_b32 v9, 4, v9
  v_mul_u32_u24 v11, 240, v10
  v_add3_u32 v16, v11, v9, s31
  v_mul_u32_u24 v11, 7168, v10
  v_add_u32 v24, v11, v9
  v_add_u32 v9, 64, v1
  v_mul_u32_u24 v10, 4682, v9
  v_lshrrev_b32 v10, 16, v10
  v_mul_u32_u24 v11, 14, v10
  v_sub_u32 v9, v9, v11
  v_lshlrev_b32 v9, 4, v9
  v_mul_u32_u24 v11, 240, v10
  v_add3_u32 v17, v11, v9, s31
  v_mul_u32_u24 v11, 7168, v10
  v_add_u32 v25, v11, v9
  v_add_u32 v9, 128, v1
  v_mul_u32_u24 v10, 4682, v9
  v_lshrrev_b32 v10, 16, v10
  v_mul_u32_u24 v11, 14, v10
  v_sub_u32 v9, v9, v11
  v_lshlrev_b32 v9, 4, v9
  v_mul_u32_u24 v11, 240, v10
  v_add3_u32 v18, v11, v9, s31
  v_mul_u32_u24 v11, 7168, v10
  v_add_u32 v26, v11, v9
  v_add_u32 v9, 192, v1
  v_mul_u32_u24 v10, 4682, v9
  v_lshrrev_b32 v10, 16, v10
  v_mul_u32_u24 v11, 14, v10
  v_sub_u32 v9, v9, v11
  v_lshlrev_b32 v9, 4, v9
  v_mul_u32_u24 v11, 240, v10
  v_add3_u32 v19, v11, v9, s31
  v_mul_u32_u24 v11, 7168, v10
  v_add_u32 v27, v11, v9
  v_add_u32 v9, 256, v1
  v_mul_u32_u24 v10, 4682, v9
  v_lshrrev_b32 v10, 16, v10
  v_mul_u32_u24 v11, 14, v10
  v_sub_u32 v9, v9, v11
  v_lshlrev_b32 v9, 4, v9
  v_mul_u32_u24 v11, 240, v10
  v_add3_u32 v20, v11, v9, s31
  v_mul_u32_u24 v11, 7168, v10
  v_add_u32 v28, v11, v9
  v_add_u32 v9, 320, v1
  v_mul_u32_u24 v10, 4682, v9
  v_lshrrev_b32 v10, 16, v10
  v_mul_u32_u24 v11, 14, v10
  v_sub_u32 v9, v9, v11
  v_lshlrev_b32 v9, 4, v9
  v_mul_u32_u24 v11, 240, v10
  v_add3_u32 v21, v11, v9, s31
  v_mul_u32_u24 v11, 7168, v10
  v_add_u32 v29, v11, v9
  v_add_u32 v9, 384, v1
  v_mul_u32_u24 v10, 4682, v9
  v_lshrrev_b32 v10, 16, v10
  v_mul_u32_u24 v11, 14, v10
  v_sub_u32 v9, v9, v11
  v_lshlrev_b32 v9, 4, v9
  v_mul_u32_u24 v11, 240, v10
  v_add3_u32 v22, v11, v9, s31
  v_mul_u32_u24 v11, 7168, v10
  v_add_u32 v30, v11, v9
  s_waitcnt lgkmcnt(0)
  ds_read_b128 v[128:131], v16 offset:0
  ds_read_b128 v[132:135], v17 offset:0
  ds_read_b128 v[136:139], v18 offset:0
  ds_read_b128 v[140:143], v19 offset:0
  ds_read_b128 v[144:147], v20 offset:0
  ds_read_b128 v[148:151], v21 offset:0
  ds_read_b128 v[152:155], v22 offset:0
  ds_read_b128 v[156:159], v16 offset:7680
  ds_read_b128 v[160:163], v17 offset:7680
  ds_read_b128 v[164:167], v18 offset:7680
  ds_read_b128 v[168:171], v19 offset:7680
  ds_read_b128 v[172:175], v20 offset:7680
  ds_read_b128 v[176:179], v21 offset:7680
  ds_read_b128 v[180:183], v22 offset:7680
  s_waitcnt lgkmcnt(13)
  buffer_store_dwordx4 v[128:131], v24, s[20:23], s30 offen
  s_waitcnt lgkmcnt(12)
  buffer_store_dwordx4 v[132:135], v25, s[20:23], s30 offen
  s_waitcnt lgkmcnt(11)
  buffer_store_dwordx4 v[136:139], v26, s[20:23], s30 offen
  s_waitcnt lgkmcnt(10)
  buffer_store_dwordx4 v[140:143], v27, s[20:23], s30 offen
  s_waitcnt lgkmcnt(9)
  buffer_store_dwordx4 v[144:147], v28, s[20:23], s30 offen
  s_waitcnt lgkmcnt(8)
  buffer_store_dwordx4 v[148:151], v29, s[20:23], s30 offen
  s_waitcnt lgkmcnt(7)
  buffer_store_dwordx4 v[152:155], v30, s[20:23], s30 offen
  s_waitcnt lgkmcnt(6)
  buffer_store_dwordx4 v[156:159], v24, s[20:23], s35 offen
  s_waitcnt lgkmcnt(5)
  buffer_store_dwordx4 v[160:163], v25, s[20:23], s35 offen
  s_waitcnt lgkmcnt(4)
  buffer_store_dwordx4 v[164:167], v26, s[20:23], s35 offen
  s_waitcnt lgkmcnt(3)
  buffer_store_dwordx4 v[168:171], v27, s[20:23], s35 offen
  s_waitcnt lgkmcnt(2)
  buffer_store_dwordx4 v[172:175], v28, s[20:23], s35 offen
  s_waitcnt lgkmcnt(1)
  buffer_store_dwordx4 v[176:179], v29, s[20:23], s35 offen
  s_waitcnt lgkmcnt(0)
  buffer_store_dwordx4 v[180:183], v30, s[20:23], s35 offen
  s_endpgm
G1_LOADER:
  s_sub_u32 s3, s3, 4
  v_lshrrev_b32 v3, 3, v1
  v_and_b32 v4, 7, v1
  v_lshrrev_b32 v5, 4, v1
  s_lshl_b32 s28, s3, 5
  s_add_u32 s28, s28, s26
  v_add_u32 v6, 0, v5
  v_xor_b32 v6, v6, v4
  v_add_u32 v7, 0, v3
  v_add_u32 v7, s28, v7
  v_mul_u32_u24 v7, 2048, v7
  v_lshl_add_u32 v8, v6, 4, v7
  v_add_u32 v6, 4, v5
  v_xor_b32 v6, v6, v4
  v_add_u32 v7, 8, v3
  v_add_u32 v7, s28, v7
  v_mul_u32_u24 v7, 2048, v7
  v_lshl_add_u32 v9, v6, 4, v7
  v_add_u32 v6, 0, v5
  v_xor_b32 v6, v6, v4
  v_add_u32 v7, 16, v3
  v_add_u32 v7, s28, v7
  v_mul_u32_u24 v7, 2048, v7
  v_lshl_add_u32 v10, v6, 4, v7
  v_add_u32 v6, 4, v5
  v_xor_b32 v6, v6, v4
  v_add_u32 v7, 24, v3
  v_add_u32 v7, s28, v7
  v_mul_u32_u24 v7, 2048, v7
  v_lshl_add_u32 v11, v6, 4, v7
  s_mul_i32 s29, s3, 448
  s_add_u32 s29, s29, 0
  v_add_u32 v6, s29, v1
  v_mul_u32_u24 v7, 2341, v6
  v_lshrrev_b32 v7, 16, v7
  v_mul_u32_u24 v20, 28, v7
  v_sub_u32 v6, v6, v20
  v_bfe_u32 v20, v7, 3, 1
  v_lshlrev_b32 v20, 1, v20
  v_xor_b32 v6, v6, v20
  v_mul_u32_u24 v7, 7168, v7
  v_lshl_add_u32 v7, v6, 4, v7
  s_lshl_b32 s29, s27, 1
  v_add_u32 v12, s29, v7
  s_mul_i32 s29, s3, 448
  s_add_u32 s29, s29, 64
  v_add_u32 v6, s29, v1
  v_mul_u32_u24 v7, 2341, v6
  v_lshrrev_b32 v7, 16, v7
  v_mul_u32_u24 v20, 28, v7
  v_sub_u32 v6, v6, v20
  v_bfe_u32 v20, v7, 3, 1
  v_lshlrev_b32 v20, 1, v20
  v_xor_b32 v6, v6, v20
  v_mul_u32_u24 v7, 7168, v7
  v_lshl_add_u32 v7, v6, 4, v7
  s_lshl_b32 s29, s27, 1
  v_add_u32 v13, s29, v7
  s_mul_i32 s29, s3, 448
  s_add_u32 s29, s29, 128
  v_add_u32 v6, s29, v1
  v_mul_u32_u24 v7, 2341, v6
  v_lshrrev_b32 v7, 16, v7
  v_mul_u32_u24 v20, 28, v7
  v_sub_u32 v6, v6, v20
  v_bfe_u32 v20, v7, 3, 1
  v_lshlrev_b32 v20, 1, v20
  v_xor_b32 v6, v6, v20
  v_mul_u32_u24 v7, 7168, v7
  v_lshl_add_u32 v7, v6, 4, v7
  s_lshl_b32 s29, s27, 1
  v_add_u32 v14, s29, v7
  s_mul_i32 s29, s3, 448
  s_add_u32 s29, s29, 192
  v_add_u32 v6, s29, v1
  v_mul_u32_u24 v7, 2341, v6
  v_lshrrev_b32 v7, 16, v7
  v_mul_u32_u24 v20, 28, v7
  v_sub_u32 v6, v6, v20
  v_bfe_u32 v20, v7, 3, 1
  v_lshlrev_b32 v20, 1, v20
  v_xor_b32 v6, v6, v20
  v_mul_u32_u24 v7, 7168, v7
  v_lshl_add_u32 v7, v6, 4, v7
  s_lshl_b32 s29, s27, 1
  v_add_u32 v15, s29, v7
  s_mul_i32 s29, s3, 448
  s_add_u32 s29, s29, 256
  v_add_u32 v6, s29, v1
  v_mul_u32_u24 v7, 2341, v6
  v_lshrrev_b32 v7, 16, v7
  v_mul_u32_u24 v20, 28, v7
  v_sub_u32 v6, v6, v20
  v_bfe_u32 v20, v7, 3, 1
  v_lshlrev_b32 v20, 1, v20
  v_xor_b32 v6, v6, v20
  v_mul_u32_u24 v7, 7168, v7
  v_lshl_add_u32 v7, v6, 4, v7
  s_lshl_b32 s29, s27, 1
  v_add_u32 v16, s29, v7
  s_mul_i32 s29, s3, 448
  s_add_u32 s29, s29, 320
  v_add_u32 v6, s29, v1
  v_mul_u32_u24 v7, 2341, v6
  v_lshrrev_b32 v7, 16, v7
  v_mul_u32_u24 v20, 28, v7
  v_sub_u32 v6, v6, v20
  v_bfe_u32 v20, v7, 3, 1
  v_lshlrev_b32 v20, 1, v20
  v_xor_b32 v6, v6, v20
  v_mul_u32_u24 v7, 7168, v7
  v_lshl_add_u32 v7, v6, 4, v7
  s_lshl_b32 s29, s27, 1
  v_add_u32 v17, s29, v7
  s_mul_i32 s29, s3, 448
  s_add_u32 s29, s29, 384
  v_add_u32 v6, s29, v1
  v_mul_u32_u24 v7, 2341, v6
  v_lshrrev_b32 v7, 16, v7
  v_mul_u32_u24 v20, 28, v7
  v_sub_u32 v6, v6, v20
  v_bfe_u32 v20, v7, 3, 1
  v_lshlrev_b32 v20, 1, v20
  v_xor_b32 v6, v6, v20
  v_mul_u32_u24 v7, 7168, v7
  v_lshl_add_u32 v7, v6, 4, v7
  s_lshl_b32 s29, s27, 1
  v_add_u32 v18, s29, v7
  s_mov_b32 s40, 0
  s_mov_b32 s41, 0
  s_lshl_b32 s44, s3, 12
  s_mul_i32 s45, s3, 7168
  s_add_u32 s45, s45, 16384
  s_mov_b32 s42, 0
  s_add_u32 m0, s42, s44
  s_nop 0
  buffer_load_dwordx4 v8, s[16:19], s40 offen lds
  s_add_u32 m0, m0, 1024
  s_nop 0
  buffer_load_dwordx4 v9, s[16:19], s40 offen lds
  s_add_u32 m0, m0, 1024
  s_nop 0
  buffer_load_dwordx4 v10, s[16:19], s40 offen lds
  s_add_u32 m0, m0, 1024
  s_nop 0
  buffer_load_dwordx4 v11, s[16:19], s40 offen lds
  s_add_u32 m0, s42, s45
  s_nop 0
  buffer_load_dwordx4 v12, s[12:15], s41 offen lds
  s_add_u32 m0, m0, 1024
  s_nop 0
  buffer_load_dwordx4 v13, s[12:15], s41 offen lds
  s_add_u32 m0, m0, 1024
  s_nop 0
  buffer_load_dwordx4 v14, s[12:15], s41 offen lds
  s_add_u32 m0, m0, 1024
  s_nop 0
  buffer_load_dwordx4 v15, s[12:15], s41 offen lds
  s_add_u32 m0, m0, 1024
  s_nop 0
  buffer_load_dwordx4 v16, s[12:15], s41 offen lds
  s_add_u32 m0, m0, 1024
  s_nop 0
  buffer_load_dwordx4 v17, s[12:15], s41 offen lds
  s_add_u32 m0, m0, 1024
  s_nop 0
  buffer_load_dwordx4 v18, s[12:15], s41 offen lds
  s_add_u32 s40, s40, 128
  s_add_u32 s41, s41, 458752
  s_mov_b32 s42, 45056
  s_add_u32 m0, s42, s44
  s_nop 0
  buffer_load_dwordx4 v8, s[16:19], s40 offen lds
  s_add_u32 m0, m0, 1024
  s_nop 0
  buffer_load_dwordx4 v9, s[16:19], s40 offen lds
  s_add_u32 m0, m0, 1024
  s_nop 0
  buffer_load_dwordx4 v10, s[16:19], s40 offen lds
  s_add_u32 m0, m0, 1024
  s_nop 0
  buffer_load_dwordx4 v11, s[16:19], s40 offen lds
  s_add_u32 m0, s42, s45
  s_nop 0
  buffer_load_dwordx4 v12, s[12:15], s41 offen lds
  s_add_u32 m0, m0, 1024
  s_nop 0
  buffer_load_dwordx4 v13, s[12:15], s41 offen lds
  s_add_u32 m0, m0, 1024
  s_nop 0
  buffer_load_dwordx4 v14, s[12:15], s41 offen lds
  s_add_u32 m0, m0, 1024
  s_nop 0
  buffer_load_dwordx4 v15, s[12:15], s41 offen lds
  s_add_u32 m0, m0, 1024
  s_nop 0
  buffer_load_dwordx4 v16, s[12:15], s41 offen lds
  s_add_u32 m0, m0, 1024
  s_nop 0
  buffer_load_dwordx4 v17, s[12:15], s41 offen lds
  s_add_u32 m0, m0, 1024
  s_nop 0
  buffer_load_dwordx4 v18, s[12:15], s41 offen lds
  s_add_u32 s40, s40, 128
  s_add_u32 s41, s41, 458752
  s_mov_b32 s42, 90112
  s_add_u32 m0, s42, s44
  s_nop 0
  buffer_load_dwordx4 v8, s[16:19], s40 offen lds
  s_add_u32 m0, m0, 1024
  s_nop 0
  buffer_load_dwordx4 v9, s[16:19], s40 offen lds
  s_add_u32 m0, m0, 1024
  s_nop 0
  buffer_load_dwordx4 v10, s[16:19], s40 offen lds
  s_add_u32 m0, m0, 1024
  s_nop 0
  buffer_load_dwordx4 v11, s[16:19], s40 offen lds
  s_add_u32 m0, s42, s45
  s_nop 0
  buffer_load_dwordx4 v12, s[12:15], s41 offen lds
  s_add_u32 m0, m0, 1024
  s_nop 0
  buffer_load_dwordx4 v13, s[12:15], s41 offen lds
  s_add_u32 m0, m0, 1024
  s_nop 0
  buffer_load_dwordx4 v14, s[12:15], s41 offen lds
  s_add_u32 m0, m0, 1024
  s_nop 0
  buffer_load_dwordx4 v15, s[12:15], s41 offen lds
  s_add_u32 m0, m0, 1024
  s_nop 0
  buffer_load_dwordx4 v16, s[12:15], s41 offen lds
  s_add_u32 m0, m0, 1024
  s_nop 0
  buffer_load_dwordx4 v17, s[12:15], s41 offen lds
  s_add_u32 m0, m0, 1024
  s_nop 0
  buffer_load_dwordx4 v18, s[12:15], s41 offen lds
  s_add_u32 s40, s40, 128
  s_add_u32 s41, s41, 458752
  s_waitcnt vmcnt(22)
  s_barrier
  s_mov_b32 s42, 0
  s_mov_b32 s43, 13
G1_LLOOP:
  s_waitcnt vmcnt(11)
  s_barrier
  s_add_u32 m0, s42, s44
  s_nop 0
  buffer_load_dwordx4 v8, s[16:19], s40 offen lds
  s_add_u32 m0, m0, 1024
  s_nop 0
  buffer_load_dwordx4 v9, s[16:19], s40 offen lds
  s_add_u32 m0, m0, 1024
  s_nop 0
  buffer_load_dwordx4 v10, s[16:19], s40 offen lds
  s_add_u32 m0, m0, 1024
  s_nop 0
  buffer_load_dwordx4 v11, s[16:19], s40 offen lds
  s_add_u32 m0, s42, s45
  s_nop 0
  buffer_load_dwordx4 v12, s[12:15], s41 offen lds
  s_add_u32 m0, m0, 1024
  s_nop 0
  buffer_load_dwordx4 v13, s[12:15], s41 offen lds
  s_add_u32 m0, m0, 1024
  s_nop 0
  buffer_load_dwordx4 v14, s[12:15], s41 offen lds
  s_add_u32 m0, m0, 1024
  s_nop 0
  buffer_load_dwordx4 v15, s[12:15], s41 offen lds
  s_add_u32 m0, m0, 1024
  s_nop 0
  buffer_load_dwordx4 v16, s[12:15], s41 offen lds
  s_add_u32 m0, m0, 1024
  s_nop 0
  buffer_load_dwordx4 v17, s[12:15], s41 offen lds
  s_add_u32 m0, m0, 1024
  s_nop 0
  buffer_load_dwordx4 v18, s[12:15], s41 offen lds
  s_add_u32 s40, s40, 128
  s_add_u32 s41, s41, 458752
  s_add_u32 s42, s42, 45056
  s_cmp_eq_u32 s42, 135168
  s_cselect_b32 s42, 0, s42
  s_sub_u32 s43, s43, 1
  s_cmp_lg_u32 s43, 0
  s_cbranch_scc1 G1_LLOOP
  s_waitcnt vmcnt(11)
  s_barrier
  s_waitcnt vmcnt(0)
  s_barrier
  s_load_dwordx2 s[48:49], s[0:1], 56
  s_lshl_b32 s46, s2, 2
  s_add_u32 s46, s46, s3
  s_mul_i32 s46, s46, 7168
  v_lshlrev_b32 v6, 4, v1
  s_waitcnt lgkmcnt(0)
  s_mov_b32 s52, s48
  s_mov_b32 s53, s49
  s_mov_b32 s54, 7340032
  s_mov_b32 s55, 0x20000
  buffer_load_dwordx4 v[32:35], v6, s[52:55], s46 offen offset:0
  buffer_load_dwordx4 v[36:39], v6, s[52:55], s46 offen offset:1024
  buffer_load_dwordx4 v[40:43], v6, s[52:55], s46 offen offset:2048
  buffer_load_dwordx4 v[44:47], v6, s[52:55], s46 offen offset:3072
  s_add_u32 s46, s46, 4096
  buffer_load_dwordx4 v[48:51], v6, s[52:55], s46 offen offset:0
  buffer_load_dwordx4 v[52:55], v6, s[52:55], s46 offen offset:1024
  buffer_load_dwordx4 v[56:59], v6, s[52:55], s46 offen offset:2048
  s_waitcnt vmcnt(0)
G1_END:
  s_endpgm
.globl ffn2_kernel
.p2align 8
.type ffn2_kernel,@function
ffn2_kernel:
  s_cmp_ge_u32 s2, 256
  s_cbranch_scc1 G2_END
  s_load_dwordx2 s[4:5], s[0:1], 56
  s_load_dwordx2 s[8:9], s[0:1], 80
  s_load_dwordx2 s[10:11], s[0:1], 64
  v_and_b32 v1, 63, v0
  v_lshrrev_b32 v2, 6, v0
  s_and_b32 s24, s2, 7
  v_readfirstlane_b32 s3, v2
  s_lshr_b32 s25, s2, 3
  s_and_b32 s26, s24, 3
  s_lshl_b32 s26, s26, 2
  s_and_b32 s27, s25, 3
  s_add_u32 s26, s26, s27
  s_lshr_b32 s27, s24, 2
  s_lshl_b32 s27, s27, 3
  s_lshr_b32 s28, s25, 2
  s_add_u32 s27, s27, s28
  s_lshl_b32 s26, s26, 7
  s_mul_i32 s27, s27, 64
  s_waitcnt lgkmcnt(0)
  s_mov_b32 s12, s4
  s_mov_b32 s13, s5
  s_mov_b32 s14, 7340032
  s_mov_b32 s15, 0x20000
  s_add_u32 s16, s8, 10485760
  s_addc_u32 s17, s9, 0
  s_mov_b32 s18, 14680064
  s_mov_b32 s19, 0x20000
  s_mov_b32 s20, s10
  s_mov_b32 s21, s11
  s_mov_b32 s22, 4194304
  s_mov_b32 s23, 0x20000
  s_add_u32 s36, s8, 5242880
  s_addc_u32 s37, s9, 0
  s_mov_b32 s38, 4194304
  s_mov_b32 s39, 0x20000
  s_cmp_ge_u32 s3, 4
  s_cbranch_scc1 G2_LOADER
  s_and_b32 s28, s3, 1
  s_lshr_b32 s29, s3, 1
  v_and_b32 v3, 15, v1
  v_lshrrev_b32 v4, 4, v1
  v_mov_b32 v128, 0
  v_mov_b32 v129, 0
  v_mov_b32 v130, 0
  v_mov_b32 v131, 0
  v_mov_b32 v132, 0
  v_mov_b32 v133, 0
  v_mov_b32 v134, 0
  v_mov_b32 v135, 0
  v_mov_b32 v136, 0
  v_mov_b32 v137, 0
  v_mov_b32 v138, 0
  v_mov_b32 v139, 0
  v_mov_b32 v140, 0
  v_mov_b32 v141, 0
  v_mov_b32 v142, 0
  v_mov_b32 v143, 0
  v_mov_b32 v144, 0
  v_mov_b32 v145, 0
  v_mov_b32 v146, 0
  v_mov_b32 v147, 0
  v_mov_b32 v148, 0
  v_mov_b32 v149, 0
  v_mov_b32 v150, 0
  v_mov_b32 v151, 0
  v_mov_b32 v152, 0
  v_mov_b32 v153, 0
  v_mov_b32 v154, 0
  v_mov_b32 v155, 0
  v_mov_b32 v156, 0
  v_mov_b32 v157, 0
  v_mov_b32 v158, 0
  v_mov_b32 v159, 0
  v_lshrrev_b32 v5, 1, v3
  v_xor_b32 v5, v5, v4
  v_lshlrev_b32 v5, 4, v5
  v_lshl_add_u32 v5, v3, 7, v5
  s_lshl_b32 s30, s28, 13
  v_add_u32 v8, s30, v5
  v_xor_b32 v9, 64, v8
  v_lshrrev_b32 v5, 2, v3
  v_and_b32 v6, 3, v3
  v_lshl_add_u32 v7, v4, 3, v5
  v_mul_u32_u24 v7, 128, v7
  v_lshl_add_u32 v7, v6, 3, v7
  v_add_u32 v7, 32768, v7
  v_lshrrev_b32 v5, 3, v3
  v_and_b32 v12, 1, v4
  v_lshl_or_b32 v5, v12, 1, v5
  s_lshl_b32 s30, s29, 1
  v_xor_b32 v12, s30, v5
  v_lshl_add_u32 v10, v12, 5, v7
  v_xor_b32 v12, 1, v12
  v_lshl_add_u32 v11, v12, 5, v7
  s_lshl_b32 s30, s28, 6
  s_add_u32 s30, s30, s26
  v_add_u32 v5, s30, v3
  v_lshlrev_b32 v5, 11, v5
  s_lshl_b32 s31, s29, 5
  s_add_u32 s31, s31, s27
  s_lshl_b32 s31, s31, 1
  v_lshl_add_u32 v13, v4, 3, v5
  v_add_u32 v13, s31, v13
  s_mov_b32 s30, 0
  buffer_load_dwordx2 v[96:97], v13, s[36:39], s30 offen offset:0
  s_mov_b32 s30, 32768
  buffer_load_dwordx2 v[98:99], v13, s[36:39], s30 offen offset:0
  s_mov_b32 s30, 65536
  buffer_load_dwordx2 v[100:101], v13, s[36:39], s30 offen offset:0
  s_mov_b32 s30, 98304
  buffer_load_dwordx2 v[102:103], v13, s[36:39], s30 offen offset:0
  s_mov_b32 s30, 0
  buffer_load_dwordx2 v[104:105], v13, s[36:39], s30 offen offset:32
  s_mov_b32 s30, 32768
  buffer_load_dwordx2 v[106:107], v13, s[36:39], s30 offen offset:32
  s_mov_b32 s30, 65536
  buffer_load_dwordx2 v[108:109], v13, s[36:39], s30 offen offset:32
  s_mov_b32 s30, 98304
  buffer_load_dwordx2 v[110:111], v13, s[36:39], s30 offen offset:32
  s_waitcnt lgkmcnt(0)
  s_barrier
  ds_read_b64_tr_b16 v[32:33], v10 offset:0
  ds_read_b64_tr_b16 v[34:35], v10 offset:512
  ds_read_b128 v[16:19], v8 offset:0
  ds_read_b128 v[20:23], v8 offset:2048
  ds_read_b128 v[24:27], v8 offset:4096
  ds_read_b128 v[28:31], v8 offset:6144
  ds_read_b64_tr_b16 v[36:37], v11 offset:0
  ds_read_b64_tr_b16 v[38:39], v11 offset:512
  s_mov_b32 s32, 0
  s_mov_b32 s33, 27
G2_LOOP:
  s_waitcnt lgkmcnt(0)
  v_mfma_f32_16x16x32_bf16 v[128:131], v[32:35], v[16:19], v[128:131]
  ds_read_b64_tr_b16 v[56:57], v10 offset:4096
  ds_read_b64_tr_b16 v[58:59], v10 offset:4608
  v_mfma_f32_16x16x32_bf16 v[132:135], v[32:35], v[20:23], v[132:135]
  ds_read_b128 v[40:43], v9 offset:0
  ds_read_b128 v[44:47], v9 offset:2048
  v_mfma_f32_16x16x32_bf16 v[136:139], v[32:35], v[24:27], v[136:139]
  ds_read_b128 v[48:51], v9 offset:4096
  ds_read_b128 v[52:55], v9 offset:6144
  v_mfma_f32_16x16x32_bf16 v[140:143], v[32:35], v[28:31], v[140:143]
  ds_read_b64_tr_b16 v[60:61], v11 offset:4096
  ds_read_b64_tr_b16 v[62:63], v11 offset:4608
  v_mfma_f32_16x16x32_bf16 v[144:147], v[36:39], v[16:19], v[144:147]
  v_mfma_f32_16x16x32_bf16 v[148:151], v[36:39], v[20:23], v[148:151]
  v_mfma_f32_16x16x32_bf16 v[152:155], v[36:39], v[24:27], v[152:155]
  v_mfma_f32_16x16x32_bf16 v[156:159], v[36:39], v[28:31], v[156:159]
  s_waitcnt lgkmcnt(0)
  v_mfma_f32_16x16x32_bf16 v[128:131], v[56:59], v[40:43], v[128:131]
  ds_read_b64_tr_b16 v[32:33], v10 offset:8192
  ds_read_b64_tr_b16 v[34:35], v10 offset:8704
  v_mfma_f32_16x16x32_bf16 v[132:135], v[56:59], v[44:47], v[132:135]
  ds_read_b128 v[16:19], v8 offset:16384
  ds_read_b128 v[20:23], v8 offset:18432
  v_mfma_f32_16x16x32_bf16 v[136:139], v[56:59], v[48:51], v[136:139]
  ds_read_b128 v[24:27], v8 offset:20480
  ds_read_b128 v[28:31], v8 offset:22528
  v_mfma_f32_16x16x32_bf16 v[140:143], v[56:59], v[52:55], v[140:143]
  ds_read_b64_tr_b16 v[36:37], v11 offset:8192
  ds_read_b64_tr_b16 v[38:39], v11 offset:8704
  v_mfma_f32_16x16x32_bf16 v[144:147], v[60:63], v[40:43], v[144:147]
  v_mfma_f32_16x16x32_bf16 v[148:151], v[60:63], v[44:47], v[148:151]
  v_mfma_f32_16x16x32_bf16 v[152:155], v[60:63], v[48:51], v[152:155]
  v_mfma_f32_16x16x32_bf16 v[156:159], v[60:63], v[52:55], v[156:159]
  s_waitcnt lgkmcnt(0)
  v_mfma_f32_16x16x32_bf16 v[128:131], v[32:35], v[16:19], v[128:131]
  ds_read_b64_tr_b16 v[56:57], v10 offset:12288
  ds_read_b64_tr_b16 v[58:59], v10 offset:12800
  v_mfma_f32_16x16x32_bf16 v[132:135], v[32:35], v[20:23], v[132:135]
  ds_read_b128 v[40:43], v9 offset:16384
  ds_read_b128 v[44:47], v9 offset:18432
  v_mfma_f32_16x16x32_bf16 v[136:139], v[32:35], v[24:27], v[136:139]
  ds_read_b128 v[48:51], v9 offset:20480
  ds_read_b128 v[52:55], v9 offset:22528
  v_mfma_f32_16x16x32_bf16 v[140:143], v[32:35], v[28:31], v[140:143]
  ds_read_b64_tr_b16 v[60:61], v11 offset:12288
  ds_read_b64_tr_b16 v[62:63], v11 offset:12800
  v_mfma_f32_16x16x32_bf16 v[144:147], v[36:39], v[16:19], v[144:147]
  v_mfma_f32_16x16x32_bf16 v[148:151], v[36:39], v[20:23], v[148:151]
  v_mfma_f32_16x16x32_bf16 v[152:155], v[36:39], v[24:27], v[152:155]
  v_mfma_f32_16x16x32_bf16 v[156:159], v[36:39], v[28:31], v[156:159]
  s_waitcnt lgkmcnt(0)
  s_barrier
  s_add_u32 s34, s32, 49152
  s_cmp_eq_u32 s34, 147456
  s_cselect_b32 s34, 0, s34
  s_sub_u32 s35, s34, s32
  s_mov_b32 s32, s34
  v_add_u32 v8, s35, v8
  v_add_u32 v9, s35, v9
  v_add_u32 v10, s35, v10
  v_add_u32 v11, s35, v11
  v_mfma_f32_16x16x32_bf16 v[128:131], v[56:59], v[40:43], v[128:131]
  ds_read_b64_tr_b16 v[32:33], v10 offset:0
  ds_read_b64_tr_b16 v[34:35], v10 offset:512
  v_mfma_f32_16x16x32_bf16 v[132:135], v[56:59], v[44:47], v[132:135]
  ds_read_b128 v[16:19], v8 offset:0
  ds_read_b128 v[20:23], v8 offset:2048
  v_mfma_f32_16x16x32_bf16 v[136:139], v[56:59], v[48:51], v[136:139]
  ds_read_b128 v[24:27], v8 offset:4096
  ds_read_b128 v[28:31], v8 offset:6144
  v_mfma_f32_16x16x32_bf16 v[140:143], v[56:59], v[52:55], v[140:143]
  ds_read_b64_tr_b16 v[36:37], v11 offset:0
  ds_read_b64_tr_b16 v[38:39], v11 offset:512
  v_mfma_f32_16x16x32_bf16 v[144:147], v[60:63], v[40:43], v[144:147]
  v_mfma_f32_16x16x32_bf16 v[148:151], v[60:63], v[44:47], v[148:151]
  v_mfma_f32_16x16x32_bf16 v[152:155], v[60:63], v[48:51], v[152:155]
  v_mfma_f32_16x16x32_bf16 v[156:159], v[60:63], v[52:55], v[156:159]
  s_sub_u32 s33, s33, 1
  s_cmp_lg_u32 s33, 0
  s_cbranch_scc1 G2_LOOP
  s_waitcnt lgkmcnt(0)
  v_mfma_f32_16x16x32_bf16 v[128:131], v[32:35], v[16:19], v[128:131]
  ds_read_b64_tr_b16 v[56:57], v10 offset:4096
  ds_read_b64_tr_b16 v[58:59], v10 offset:4608
  v_mfma_f32_16x16x32_bf16 v[132:135], v[32:35], v[20:23], v[132:135]
  ds_read_b128 v[40:43], v9 offset:0
  ds_read_b128 v[44:47], v9 offset:2048
  v_mfma_f32_16x16x32_bf16 v[136:139], v[32:35], v[24:27], v[136:139]
  ds_read_b128 v[48:51], v9 offset:4096
  ds_read_b128 v[52:55], v9 offset:6144
  v_mfma_f32_16x16x32_bf16 v[140:143], v[32:35], v[28:31], v[140:143]
  ds_read_b64_tr_b16 v[60:61], v11 offset:4096
  ds_read_b64_tr_b16 v[62:63], v11 offset:4608
  v_mfma_f32_16x16x32_bf16 v[144:147], v[36:39], v[16:19], v[144:147]
  v_mfma_f32_16x16x32_bf16 v[148:151], v[36:39], v[20:23], v[148:151]
  v_mfma_f32_16x16x32_bf16 v[152:155], v[36:39], v[24:27], v[152:155]
  v_mfma_f32_16x16x32_bf16 v[156:159], v[36:39], v[28:31], v[156:159]
  s_waitcnt lgkmcnt(0)
  v_mfma_f32_16x16x32_bf16 v[128:131], v[56:59], v[40:43], v[128:131]
  ds_read_b64_tr_b16 v[32:33], v10 offset:8192
  ds_read_b64_tr_b16 v[34:35], v10 offset:8704
  v_mfma_f32_16x16x32_bf16 v[132:135], v[56:59], v[44:47], v[132:135]
  ds_read_b128 v[16:19], v8 offset:16384
  ds_read_b128 v[20:23], v8 offset:18432
  v_mfma_f32_16x16x32_bf16 v[136:139], v[56:59], v[48:51], v[136:139]
  ds_read_b128 v[24:27], v8 offset:20480
  ds_read_b128 v[28:31], v8 offset:22528
  v_mfma_f32_16x16x32_bf16 v[140:143], v[56:59], v[52:55], v[140:143]
  ds_read_b64_tr_b16 v[36:37], v11 offset:8192
  ds_read_b64_tr_b16 v[38:39], v11 offset:8704
  v_mfma_f32_16x16x32_bf16 v[144:147], v[60:63], v[40:43], v[144:147]
  v_mfma_f32_16x16x32_bf16 v[148:151], v[60:63], v[44:47], v[148:151]
  v_mfma_f32_16x16x32_bf16 v[152:155], v[60:63], v[48:51], v[152:155]
  v_mfma_f32_16x16x32_bf16 v[156:159], v[60:63], v[52:55], v[156:159]
  s_waitcnt lgkmcnt(0)
  v_mfma_f32_16x16x32_bf16 v[128:131], v[32:35], v[16:19], v[128:131]
  ds_read_b64_tr_b16 v[56:57], v10 offset:12288
  ds_read_b64_tr_b16 v[58:59], v10 offset:12800
  v_mfma_f32_16x16x32_bf16 v[132:135], v[32:35], v[20:23], v[132:135]
  ds_read_b128 v[40:43], v9 offset:16384
  ds_read_b128 v[44:47], v9 offset:18432
  v_mfma_f32_16x16x32_bf16 v[136:139], v[32:35], v[24:27], v[136:139]
  ds_read_b128 v[48:51], v9 offset:20480
  ds_read_b128 v[52:55], v9 offset:22528
  v_mfma_f32_16x16x32_bf16 v[140:143], v[32:35], v[28:31], v[140:143]
  ds_read_b64_tr_b16 v[60:61], v11 offset:12288
  ds_read_b64_tr_b16 v[62:63], v11 offset:12800
  v_mfma_f32_16x16x32_bf16 v[144:147], v[36:39], v[16:19], v[144:147]
  v_mfma_f32_16x16x32_bf16 v[148:151], v[36:39], v[20:23], v[148:151]
  v_mfma_f32_16x16x32_bf16 v[152:155], v[36:39], v[24:27], v[152:155]
  v_mfma_f32_16x16x32_bf16 v[156:159], v[36:39], v[28:31], v[156:159]
  s_waitcnt lgkmcnt(0)
  v_mfma_f32_16x16x32_bf16 v[128:131], v[56:59], v[40:43], v[128:131]
  v_mfma_f32_16x16x32_bf16 v[132:135], v[56:59], v[44:47], v[132:135]
  v_mfma_f32_16x16x32_bf16 v[136:139], v[56:59], v[48:51], v[136:139]
  v_mfma_f32_16x16x32_bf16 v[140:143], v[56:59], v[52:55], v[140:143]
  v_mfma_f32_16x16x32_bf16 v[144:147], v[60:63], v[40:43], v[144:147]
  v_mfma_f32_16x16x32_bf16 v[148:151], v[60:63], v[44:47], v[148:151]
  v_mfma_f32_16x16x32_bf16 v[152:155], v[60:63], v[48:51], v[152:155]
  v_mfma_f32_16x16x32_bf16 v[156:159], v[60:63], v[52:55], v[156:159]
  s_nop 7
  s_nop 1
  s_waitcnt vmcnt(0)
  v_lshlrev_b32 v20, 16, v96
  v_and_b32 v21, 0xffff0000, v96
  v_lshlrev_b32 v22, 16, v97
  v_and_b32 v23, 0xffff0000, v97
  v_add_f32 v16, v128, v20
  v_add_f32 v17, v129, v21
  v_add_f32 v18, v130, v22
  v_add_f32 v19, v131, v23
  v_cvt_pk_bf16_f32 v20, v16, v17
  v_cvt_pk_bf16_f32 v21, v18, v19
  s_mov_b32 s30, 0
  buffer_store_dwordx2 v[20:21], v13, s[20:23], s30 offen offset:0
  v_lshlrev_b32 v28, 16, v98
  v_and_b32 v29, 0xffff0000, v98
  v_lshlrev_b32 v30, 16, v99
  v_and_b32 v31, 0xffff0000, v99
  v_add_f32 v24, v132, v28
  v_add_f32 v25, v133, v29
  v_add_f32 v26, v134, v30
  v_add_f32 v27, v135, v31
  v_cvt_pk_bf16_f32 v28, v24, v25
  v_cvt_pk_bf16_f32 v29, v26, v27
  s_mov_b32 s30, 32768
  buffer_store_dwordx2 v[28:29], v13, s[20:23], s30 offen offset:0
  v_lshlrev_b32 v36, 16, v100
  v_and_b32 v37, 0xffff0000, v100
  v_lshlrev_b32 v38, 16, v101
  v_and_b32 v39, 0xffff0000, v101
  v_add_f32 v32, v136, v36
  v_add_f32 v33, v137, v37
  v_add_f32 v34, v138, v38
  v_add_f32 v35, v139, v39
  v_cvt_pk_bf16_f32 v36, v32, v33
  v_cvt_pk_bf16_f32 v37, v34, v35
  s_mov_b32 s30, 65536
  buffer_store_dwordx2 v[36:37], v13, s[20:23], s30 offen offset:0
  v_lshlrev_b32 v44, 16, v102
  v_and_b32 v45, 0xffff0000, v102
  v_lshlrev_b32 v46, 16, v103
  v_and_b32 v47, 0xffff0000, v103
  v_add_f32 v40, v140, v44
  v_add_f32 v41, v141, v45
  v_add_f32 v42, v142, v46
  v_add_f32 v43, v143, v47
  v_cvt_pk_bf16_f32 v44, v40, v41
  v_cvt_pk_bf16_f32 v45, v42, v43
  s_mov_b32 s30, 98304
  buffer_store_dwordx2 v[44:45], v13, s[20:23], s30 offen offset:0
  v_lshlrev_b32 v52, 16, v104
  v_and_b32 v53, 0xffff0000, v104
  v_lshlrev_b32 v54, 16, v105
  v_and_b32 v55, 0xffff0000, v105
  v_add_f32 v48, v144, v52
  v_add_f32 v49, v145, v53
  v_add_f32 v50, v146, v54
  v_add_f32 v51, v147, v55
  v_cvt_pk_bf16_f32 v52, v48, v49
  v_cvt_pk_bf16_f32 v53, v50, v51
  s_mov_b32 s30, 0
  buffer_store_dwordx2 v[52:53], v13, s[20:23], s30 offen offset:32
  v_lshlrev_b32 v60, 16, v106
  v_and_b32 v61, 0xffff0000, v106
  v_lshlrev_b32 v62, 16, v107
  v_and_b32 v63, 0xffff0000, v107
  v_add_f32 v56, v148, v60
  v_add_f32 v57, v149, v61
  v_add_f32 v58, v150, v62
  v_add_f32 v59, v151, v63
  v_cvt_pk_bf16_f32 v60, v56, v57
  v_cvt_pk_bf16_f32 v61, v58, v59
  s_mov_b32 s30, 32768
  buffer_store_dwordx2 v[60:61], v13, s[20:23], s30 offen offset:32
  v_lshlrev_b32 v68, 16, v108
  v_and_b32 v69, 0xffff0000, v108
  v_lshlrev_b32 v70, 16, v109
  v_and_b32 v71, 0xffff0000, v109
  v_add_f32 v64, v152, v68
  v_add_f32 v65, v153, v69
  v_add_f32 v66, v154, v70
  v_add_f32 v67, v155, v71
  v_cvt_pk_bf16_f32 v68, v64, v65
  v_cvt_pk_bf16_f32 v69, v66, v67
  s_mov_b32 s30, 65536
  buffer_store_dwordx2 v[68:69], v13, s[20:23], s30 offen offset:32
  v_lshlrev_b32 v76, 16, v110
  v_and_b32 v77, 0xffff0000, v110
  v_lshlrev_b32 v78, 16, v111
  v_and_b32 v79, 0xffff0000, v111
  v_add_f32 v72, v156, v76
  v_add_f32 v73, v157, v77
  v_add_f32 v74, v158, v78
  v_add_f32 v75, v159, v79
  v_cvt_pk_bf16_f32 v76, v72, v73
  v_cvt_pk_bf16_f32 v77, v74, v75
  s_mov_b32 s30, 98304
  buffer_store_dwordx2 v[76:77], v13, s[20:23], s30 offen offset:32
  s_endpgm
G2_LOADER:
  s_sub_u32 s3, s3, 4
  v_lshrrev_b32 v3, 3, v1
  v_and_b32 v4, 7, v1
  v_lshrrev_b32 v5, 4, v1
  s_lshl_b32 s28, s3, 5
  s_add_u32 s28, s28, s26
  v_add_u32 v6, 0, v5
  v_xor_b32 v6, v6, v4
  v_add_u32 v7, 0, v3
  v_add_u32 v7, s28, v7
  v_mul_u32_u24 v7, 7168, v7
  v_lshl_add_u32 v8, v6, 4, v7
  v_add_u32 v6, 4, v5
  v_xor_b32 v6, v6, v4
  v_add_u32 v7, 8, v3
  v_add_u32 v7, s28, v7
  v_mul_u32_u24 v7, 7168, v7
  v_lshl_add_u32 v9, v6, 4, v7
  v_add_u32 v6, 0, v5
  v_xor_b32 v6, v6, v4
  v_add_u32 v7, 16, v3
  v_add_u32 v7, s28, v7
  v_mul_u32_u24 v7, 7168, v7
  v_lshl_add_u32 v10, v6, 4, v7
  v_add_u32 v6, 4, v5
  v_xor_b32 v6, v6, v4
  v_add_u32 v7, 24, v3
  v_add_u32 v7, s28, v7
  v_mul_u32_u24 v7, 7168, v7
  v_lshl_add_u32 v11, v6, 4, v7
  s_mul_i32 s29, s3, 128
  s_add_u32 s29, s29, 0
  v_add_u32 v6, s29, v1
  v_lshrrev_b32 v7, 3, v6
  v_and_b32 v6, 7, v6
  v_bfe_u32 v20, v7, 1, 1
  v_bfe_u32 v21, v7, 3, 1
  v_lshl_or_b32 v20, v21, 1, v20
  v_lshlrev_b32 v20, 1, v20
  v_xor_b32 v6, v6, v20
  v_mul_u32_u24 v7, 2048, v7
  v_lshl_add_u32 v7, v6, 4, v7
  s_lshl_b32 s29, s27, 1
  v_add_u32 v12, s29, v7
  s_mul_i32 s29, s3, 128
  s_add_u32 s29, s29, 64
  v_add_u32 v6, s29, v1
  v_lshrrev_b32 v7, 3, v6
  v_and_b32 v6, 7, v6
  v_bfe_u32 v20, v7, 1, 1
  v_bfe_u32 v21, v7, 3, 1
  v_lshl_or_b32 v20, v21, 1, v20
  v_lshlrev_b32 v20, 1, v20
  v_xor_b32 v6, v6, v20
  v_mul_u32_u24 v7, 2048, v7
  v_lshl_add_u32 v7, v6, 4, v7
  s_lshl_b32 s29, s27, 1
  v_add_u32 v13, s29, v7
  s_mov_b32 s40, 0
  s_mov_b32 s41, 0
  s_lshl_b32 s44, s3, 12
  s_mul_i32 s45, s3, 2048
  s_add_u32 s45, s45, 32768
  s_mov_b32 s42, 0
  s_add_u32 m0, s42, s44
  s_nop 0
  buffer_load_dwordx4 v8, s[16:19], s40 offen lds
  s_add_u32 m0, m0, 1024
  s_nop 0
  buffer_load_dwordx4 v9, s[16:19], s40 offen lds
  s_add_u32 m0, m0, 1024
  s_nop 0
  buffer_load_dwordx4 v10, s[16:19], s40 offen lds
  s_add_u32 m0, m0, 1024
  s_nop 0
  buffer_load_dwordx4 v11, s[16:19], s40 offen lds
  s_add_u32 m0, m0, 13312
  s_add_u32 s46, s40, 128
  buffer_load_dwordx4 v8, s[16:19], s46 offen lds
  s_add_u32 m0, m0, 1024
  s_add_u32 s46, s40, 128
  buffer_load_dwordx4 v9, s[16:19], s46 offen lds
  s_add_u32 m0, m0, 1024
  s_add_u32 s46, s40, 128
  buffer_load_dwordx4 v10, s[16:19], s46 offen lds
  s_add_u32 m0, m0, 1024
  s_add_u32 s46, s40, 128
  buffer_load_dwordx4 v11, s[16:19], s46 offen lds
  s_add_u32 m0, s42, s45
  s_nop 0
  buffer_load_dwordx4 v12, s[12:15], s41 offen lds
  s_add_u32 m0, m0, 1024
  s_nop 0
  buffer_load_dwordx4 v13, s[12:15], s41 offen lds
  s_add_u32 m0, m0, 7168
  s_add_u32 s46, s41, 131072
  buffer_load_dwordx4 v12, s[12:15], s46 offen lds
  s_add_u32 m0, m0, 1024
  s_add_u32 s46, s41, 131072
  buffer_load_dwordx4 v13, s[12:15], s46 offen lds
  s_add_u32 s40, s40, 256
  s_add_u32 s41, s41, 262144
  s_mov_b32 s42, 49152
  s_add_u32 m0, s42, s44
  s_nop 0
  buffer_load_dwordx4 v8, s[16:19], s40 offen lds
  s_add_u32 m0, m0, 1024
  s_nop 0
  buffer_load_dwordx4 v9, s[16:19], s40 offen lds
  s_add_u32 m0, m0, 1024
  s_nop 0
  buffer_load_dwordx4 v10, s[16:19], s40 offen lds
  s_add_u32 m0, m0, 1024
  s_nop 0
  buffer_load_dwordx4 v11, s[16:19], s40 offen lds
  s_add_u32 m0, m0, 13312
  s_add_u32 s46, s40, 128
  buffer_load_dwordx4 v8, s[16:19], s46 offen lds
  s_add_u32 m0, m0, 1024
  s_add_u32 s46, s40, 128
  buffer_load_dwordx4 v9, s[16:19], s46 offen lds
  s_add_u32 m0, m0, 1024
  s_add_u32 s46, s40, 128
  buffer_load_dwordx4 v10, s[16:19], s46 offen lds
  s_add_u32 m0, m0, 1024
  s_add_u32 s46, s40, 128
  buffer_load_dwordx4 v11, s[16:19], s46 offen lds
  s_add_u32 m0, s42, s45
  s_nop 0
  buffer_load_dwordx4 v12, s[12:15], s41 offen lds
  s_add_u32 m0, m0, 1024
  s_nop 0
  buffer_load_dwordx4 v13, s[12:15], s41 offen lds
  s_add_u32 m0, m0, 7168
  s_add_u32 s46, s41, 131072
  buffer_load_dwordx4 v12, s[12:15], s46 offen lds
  s_add_u32 m0, m0, 1024
  s_add_u32 s46, s41, 131072
  buffer_load_dwordx4 v13, s[12:15], s46 offen lds
  s_add_u32 s40, s40, 256
  s_add_u32 s41, s41, 262144
  s_mov_b32 s42, 98304
  s_add_u32 m0, s42, s44
  s_nop 0
  buffer_load_dwordx4 v8, s[16:19], s40 offen lds
  s_add_u32 m0, m0, 1024
  s_nop 0
  buffer_load_dwordx4 v9, s[16:19], s40 offen lds
  s_add_u32 m0, m0, 1024
  s_nop 0
  buffer_load_dwordx4 v10, s[16:19], s40 offen lds
  s_add_u32 m0, m0, 1024
  s_nop 0
  buffer_load_dwordx4 v11, s[16:19], s40 offen lds
  s_add_u32 m0, m0, 13312
  s_add_u32 s46, s40, 128
  buffer_load_dwordx4 v8, s[16:19], s46 offen lds
  s_add_u32 m0, m0, 1024
  s_add_u32 s46, s40, 128
  buffer_load_dwordx4 v9, s[16:19], s46 offen lds
  s_add_u32 m0, m0, 1024
  s_add_u32 s46, s40, 128
  buffer_load_dwordx4 v10, s[16:19], s46 offen lds
  s_add_u32 m0, m0, 1024
  s_add_u32 s46, s40, 128
  buffer_load_dwordx4 v11, s[16:19], s46 offen lds
  s_add_u32 m0, s42, s45
  s_nop 0
  buffer_load_dwordx4 v12, s[12:15], s41 offen lds
  s_add_u32 m0, m0, 1024
  s_nop 0
  buffer_load_dwordx4 v13, s[12:15], s41 offen lds
  s_add_u32 m0, m0, 7168
  s_add_u32 s46, s41, 131072
  buffer_load_dwordx4 v12, s[12:15], s46 offen lds
  s_add_u32 m0, m0, 1024
  s_add_u32 s46, s41, 131072
  buffer_load_dwordx4 v13, s[12:15], s46 offen lds
  s_add_u32 s40, s40, 256
  s_add_u32 s41, s41, 262144
  s_waitcnt vmcnt(24)
  s_barrier
  s_mov_b32 s42, 0
  s_mov_b32 s43, 25
G2_LLOOP:
  s_waitcnt vmcnt(12)
  s_barrier
  s_add_u32 m0, s42, s44
  s_nop 0
  buffer_load_dwordx4 v8, s[16:19], s40 offen lds
  s_add_u32 m0, m0, 1024
  s_nop 0
  buffer_load_dwordx4 v9, s[16:19], s40 offen lds
  s_add_u32 m0, m0, 1024
  s_nop 0
  buffer_load_dwordx4 v10, s[16:19], s40 offen lds
  s_add_u32 m0, m0, 1024
  s_nop 0
  buffer_load_dwordx4 v11, s[16:19], s40 offen lds
  s_add_u32 m0, m0, 13312
  s_add_u32 s46, s40, 128
  buffer_load_dwordx4 v8, s[16:19], s46 offen lds
  s_add_u32 m0, m0, 1024
  s_add_u32 s46, s40, 128
  buffer_load_dwordx4 v9, s[16:19], s46 offen lds
  s_add_u32 m0, m0, 1024
  s_add_u32 s46, s40, 128
  buffer_load_dwordx4 v10, s[16:19], s46 offen lds
  s_add_u32 m0, m0, 1024
  s_add_u32 s46, s40, 128
  buffer_load_dwordx4 v11, s[16:19], s46 offen lds
  s_add_u32 m0, s42, s45
  s_nop 0
  buffer_load_dwordx4 v12, s[12:15], s41 offen lds
  s_add_u32 m0, m0, 1024
  s_nop 0
  buffer_load_dwordx4 v13, s[12:15], s41 offen lds
  s_add_u32 m0, m0, 7168
  s_add_u32 s46, s41, 131072
  buffer_load_dwordx4 v12, s[12:15], s46 offen lds
  s_add_u32 m0, m0, 1024
  s_add_u32 s46, s41, 131072
  buffer_load_dwordx4 v13, s[12:15], s46 offen lds
  s_add_u32 s40, s40, 256
  s_add_u32 s41, s41, 262144
  s_add_u32 s42, s42, 49152
  s_cmp_eq_u32 s42, 147456
  s_cselect_b32 s42, 0, s42
  s_sub_u32 s43, s43, 1
  s_cmp_lg_u32 s43, 0
  s_cbranch_scc1 G2_LLOOP
  s_waitcnt vmcnt(12)
  s_barrier
  s_waitcnt vmcnt(0)
  s_barrier
G2_END:
  s_endpgm
.section .rodata,"a"
.p2align 6
.amdhsa_kernel ln_fold_kernel
  .amdhsa_next_free_vgpr 72
  .amdhsa_next_free_sgpr 96
  .amdhsa_accum_offset 72
  .amdhsa_group_segment_fixed_size 0
  .amdhsa_kernarg_size 88
  .amdhsa_user_sgpr_count 2
  .amdhsa_user_sgpr_kernarg_segment_ptr 1
  .amdhsa_system_sgpr_workgroup_id_x 1
.end_amdhsa_kernel
.p2align 6
.amdhsa_kernel dft_hid_kernel
  .amdhsa_next_free_vgpr 296
  .amdhsa_next_free_sgpr 96
  .amdhsa_accum_offset 256
  .amdhsa_group_segment_fixed_size 0
  .amdhsa_kernarg_size 88
  .amdhsa_user_sgpr_count 2
  .amdhsa_user_sgpr_kernarg_segment_ptr 1
  .amdhsa_system_sgpr_workgroup_id_x 1
.end_amdhsa_kernel
.p2align 6
.amdhsa_kernel dft_seq_kernel
  .amdhsa_next_free_vgpr 320
  .amdhsa_next_free_sgpr 96
  .amdhsa_accum_offset 256
  .amdhsa_group_segment_fixed_size 0
  .amdhsa_kernarg_size 88
  .amdhsa_user_sgpr_count 2
  .amdhsa_user_sgpr_kernarg_segment_ptr 1
  .amdhsa_system_sgpr_workgroup_id_x 1
.end_amdhsa_kernel
.p2align 6
.amdhsa_kernel ffn1_kernel
  .amdhsa_next_free_vgpr 240
  .amdhsa_next_free_sgpr 96
  .amdhsa_accum_offset 240
  .amdhsa_group_segment_fixed_size 0
  .amdhsa_kernarg_size 88
  .amdhsa_user_sgpr_count 2
  .amdhsa_user_sgpr_kernarg_segment_ptr 1
  .amdhsa_system_sgpr_workgroup_id_x 1
.end_amdhsa_kernel
.p2align 6
.amdhsa_kernel ffn2_kernel
  .amdhsa_next_free_vgpr 160
  .amdhsa_next_free_sgpr 96
  .amdhsa_accum_offset 160
  .amdhsa_group_segment_fixed_size 0
  .amdhsa_kernarg_size 88
  .amdhsa_user_sgpr_count 2
  .amdhsa_user_sgpr_kernarg_segment_ptr 1
  .amdhsa_system_sgpr_workgroup_id_x 1
.end_amdhsa_kernel
```
